```python
import torch

def _softmax(x, axis=-1):
    return torch.softmax(x, dim=axis)
def _gelu(x):
    return torch.nn.functional.gelu(x, approximate="tanh")
def _silu(x):
    return torch.nn.functional.silu(x)
def _sigmoid(x):
    return torch.sigmoid(x)
def _layernorm(x, axis=-1, eps=1e-5):
    m = x.mean(dim=axis, keepdim=True)
    v = x.var(dim=axis, keepdim=True, unbiased=False)
    return (x - m) / torch.sqrt(v + eps)
def _scatter_add(tgt, idx, src, axis=0):
    return tgt.clone().index_add_(axis, idx, src)
def _segment_sum(src, seg, n):
    out = torch.zeros((n,) + src.shape[1:], dtype=src.dtype)
    return out.index_add_(0, seg, src)
def _pad(x, pw):
    flat = tuple(v for pair in reversed(pw) for v in pair)
    return torch.nn.functional.pad(x, flat)

kernel_name = 'gated_mix__ssm_conv_s5__dense_activation_mish__prompt'

def setup_inputs():

    _w = (lambda a: (lambda t: t.to(torch.bfloat16) if t.is_floating_point() else t)(torch.as_tensor(a)))
    def _A_setup():
        B, S, D = 1, 2048, 448
        P = D
        Lambda_re = -0.5 * (lambda _x: torch.exp(torch.as_tensor(_x)))((lambda *s: torch.randn(*s, dtype=torch.bfloat16) * 0.1)(P))
        Lambda_im = (lambda *s: torch.randn(*s, dtype=torch.bfloat16) * 0.2)(P) * 1.0
        B_re = (lambda *s: torch.randn(*s, dtype=torch.bfloat16) * 0.2)(P, D) * (D ** -0.5)
        B_im = (lambda *s: torch.randn(*s, dtype=torch.bfloat16) * 0.2)(P, D) * (D ** -0.5)
        C_re = (lambda *s: torch.randn(*s, dtype=torch.bfloat16) * 0.2)(D, P) * (P ** -0.5)
        C_im = (lambda *s: torch.randn(*s, dtype=torch.bfloat16) * 0.2)(D, P) * (P ** -0.5)
        log_dt = (lambda *s: torch.randn(*s, dtype=torch.bfloat16) * 0.1)(P) * 0.3 - 2.0
        Dskip = (lambda *s: torch.randn(*s, dtype=torch.bfloat16) * 0.05)(D)
        return {
            "x": _w((lambda *s: torch.randn(*s, dtype=torch.bfloat16) * 0.05)(B, S, D)),
            "Lambda_re": _w(Lambda_re),
            "Lambda_im": _w(Lambda_im),
            "B_re": _w(B_re),
            "B_im": _w(B_im),
            "C_re": _w(C_re),
            "C_im": _w(C_im),
            "log_dt": _w(log_dt),
            "Dskip": _w(Dskip),
        }
    _A_in = _A_setup()

    def _B_setup():
        B, S, D, F = 1, 2048, 448, 1792
        return {
            "x": _w((lambda *s: torch.randn(*s, dtype=torch.bfloat16) * 0.05)(B, S, D)),
            "w1": _w((lambda *s: torch.randn(*s, dtype=torch.bfloat16) * 3.2)(D, F) * (D ** -0.5)),
            "b1": _w((lambda *s: torch.randn(*s, dtype=torch.bfloat16) * 0.05)(F)),
            "w2": _w((lambda *s: torch.randn(*s, dtype=torch.bfloat16) * 0.05)(F, D) * (F ** -0.5)),
        }
    _B_in = _B_setup()

    return {
        "A_x": _A_in["x"],
        "A_Lambda_re": _A_in["Lambda_re"],
        "A_Lambda_im": _A_in["Lambda_im"],
        "A_B_re": _A_in["B_re"],
        "A_B_im": _A_in["B_im"],
        "A_C_re": _A_in["C_re"],
        "A_C_im": _A_in["C_im"],
        "A_log_dt": _A_in["log_dt"],
        "A_Dskip": _A_in["Dskip"],
        "B_x": _B_in["x"],
        "B_w1": _B_in["w1"],
        "B_b1": _B_in["b1"],
        "B_w2": _B_in["w2"],
        "gate_w": _w((lambda *s: torch.randn(*s, dtype=torch.bfloat16) * 0.05)(448) * 16.0),
    }

def reference(A_x, A_Lambda_re, A_Lambda_im, A_B_re, A_B_im, A_C_re, A_C_im, A_log_dt, A_Dskip, B_x, B_w1, B_b1, B_w2, gate_w):
    def _A_ref(x, Lambda_re, Lambda_im, B_re, B_im, C_re, C_im, log_dt, Dskip):
        Bsz, L, H = x.shape
        Lam = Lambda_re + 1j * Lambda_im
        Bmat = B_re + 1j * B_im
        Cmat = C_re + 1j * C_im
        dt = torch.exp(log_dt)
        Lam_bar = torch.exp(dt * Lam)
        B_bar = ((Lam_bar - 1.0) / Lam)[:, None] * Bmat
        Bu = torch.einsum("bld,pd->blp", x + 0j, B_bar)
        h = torch.zeros_like(Bu[:, 0, :])
        hs = []
        for t in range(L):
            h = Lam_bar[None, :] * h + Bu[:, t, :]
            hs.append(h)
        hseq = torch.stack(hs, 1)
        y = 2.0 * torch.einsum("blp,dp->bld", hseq, Cmat).real + x * Dskip[None, None, :]
        return y

    def _B_ref(x, w1, b1, w2):
        h = torch.einsum("bsd,df->bsf", x, w1) + b1
        sp = torch.log1p(torch.exp(-torch.abs(h))) + torch.where(h > 0, h, torch.zeros_like(h))
        act = h * torch.tanh(sp)
        return torch.einsum("bsf,fd->bsd", act, w2)

    x = A_x
    g = _sigmoid((x * gate_w).sum(-1, keepdims=True))
    a = _A_ref(x, A_Lambda_re, A_Lambda_im, A_B_re, A_B_im, A_C_re, A_C_im, A_log_dt, A_Dskip)
    b = _B_ref(x, B_w1, B_b1, B_w2)
    return g * a + (1 - g) * b
```

```asm
; @launch grid=(256,1,1) block=(256,1,1) lds=163840
.amdgcn_target "amdgcn-amd-amdhsa--gfx950"
.text
.globl gated_mix__ssm_conv_s5__dense_activation_mish__prompt_kernel
.p2align 8
.type gated_mix__ssm_conv_s5__dense_activation_mish__prompt_kernel,@function
gated_mix__ssm_conv_s5__dense_activation_mish__prompt_kernel:
s_cmp_ge_u32 s2, 256
s_cbranch_scc1 L_exit
s_load_dwordx16 s[16:31], s[0:1], 0
s_load_dwordx16 s[32:47], s[0:1], 64
s_load_dwordx2 s[48:49], s[0:1], 128
s_getpc_b64 s[50:51]
L_pc0:
s_lshr_b32 s12, s2, 5
s_sub_u32 s12, s12, 1
s_cbranch_scc0 L_main
v_lshlrev_b32 v57, 7, v0
v_min_u32 v57, L_pe-L_pc0, v57
global_load_dword v191, v57, s[50:51]
s_branch L_pf
L_main:
v_lshrrev_b32 v62, 6, v0
v_and_b32 v1, 63, v0
s_and_b32 s50, 7, s2
v_readfirstlane_b32 s3, v62
v_lshrrev_b32 v62, 4, v1
v_lshrrev_b32 v57, 3, v1
v_xor_b32 v58, v62, v1
v_lshrrev_b32 v3, 5, v1
v_and_b32 v58, 7, v58
v_and_b32 v61, 3, v57
v_lshlrev_b32 v58, 4, v58
s_add_u32 s13, s50, s12
s_cmp_ge_u32 s13, 7
s_cselect_b32 s51, 7, 0
s_sub_u32 s13, s13, s51
s_bfe_u32 s51, s2, 0x20003
s_lshl2_add_u32 s11, s50, s51
s_lshl_b32 s4, s13, 7
s_lshl3_add_u32 s50, s11, s3
s_mul_i32 s52, s50, 7168
v_lshl_add_u32 v61, v3, 5, v61
s_sub_u32 s54, 1835008, s52
v_mul_u32_u24 v61, 896, v61
s_mov_b32 s55, 0x20000
s_lshl_b32 s100, s3, 11
v_add_u32 v4, v61, v58
s_add_u32 m0, s100, 98304
s_waitcnt lgkmcnt(0)
s_add_u32 s52, s52, s16
s_addc_u32 s53, s17, 0
buffer_load_dwordx4 v4, s[52:55], s4 offen offset:0 lds
v_xor_b32 v59, 64, v58
s_lshl_b32 s15, s3, 12
v_add_u32 v5, v61, v59
s_lshl2_add_u32 s51, s12, s3
v_add_u32 v5, 2560, v5
buffer_load_dwordx4 v5, s[52:55], s4 offen offset:1024 lds
s_add_u32 m0, s15, 0
s_mul_i32 s56, s51, 14336
v_mul_u32_u24 v61, 896, v57
s_sub_u32 s58, 401408, s56
s_mov_b32 s59, 0x20000
s_add_u32 s60, s56, s24
s_addc_u32 s61, s25, 0
s_add_u32 s56, s56, s22
s_addc_u32 s57, s23, 0
v_add_u32 v6, v61, v58
buffer_load_dwordx4 v6, s[56:59], s4 offen offset:0 lds
s_add_u32 s62, s58, 1024
s_mov_b32 s63, 0x20000
s_sub_u32 s60, s60, 1024
s_subb_u32 s61, s61, 0
v_add_u32 v7, v61, v59
v_add_u32 v8, 5120, v6
buffer_load_dwordx4 v7, s[60:63], s4 offen offset:1024 lds
s_load_dword s14, s[48:49], 0
v_add_u32 v9, 5120, v7
v_and_b32 v2, 31, v1
v_and_b32 v60, 1, v62
v_lshlrev_b32 v60, 2, v60
v_xor_b32 v60, v60, v1
v_and_b32 v60, 7, v60
v_lshlrev_b32 v60, 4, v60
buffer_load_dwordx4 v8, s[56:59], s4 offen offset:2048 lds
v_add_u32 v18, v61, v60
v_mul_u32_u24 v61, 3584, v57
v_add_u32 v10, v61, v60
v_add_u32 v57, s13, v57
v_subrev_u32 v58, 7, v57
v_min_u32 v57, v57, v58
v_and_b32 v58, 7, v1
v_lshlrev_b32 v61, 2, v58
v_lshl_add_u32 v57, v57, 7, v61
buffer_load_dwordx4 v9, s[60:63], s4 offen offset:3072 lds
v_lshl_add_u32 v57, s3, 5, v57
v_lshrrev_b32 v59, 4, v2
v_lshl_add_u32 v59, v59, 3, v58
s_lshl_b32 s50, s51, 4
v_add_lshl_u32 v59, v59, s50, 1
s_lshl_b32 s50, s51, 5
v_add_lshl_u32 v58, v2, s50, 2
s_and_b32 s101, s3, 1
s_lshl1_add_u32 s50, s12, s101
s_lshl_b32 s50, s50, 5
v_add_lshl_u32 v60, v2, s50, 1
s_lshr_b32 s50, s15, 3
s_add_u32 m0, s50, 157696
global_load_ushort v108, v59, s[18:19]
s_add_u32 s5, s4, 128
s_cmp_ge_u32 s5, 896
s_cselect_b32 s5, 0, s5
s_add_u32 s6, s5, 128
s_cmp_ge_u32 s6, 896
s_cselect_b32 s6, 0, s6
global_load_lds_dword v57, s[42:43]
s_add_u32 m0, s50, 157952
s_add_u32 s7, s6, 128
s_cmp_ge_u32 s7, 896
s_cselect_b32 s7, 0, s7
s_add_u32 s8, s7, 128
global_load_ushort v109, v59, s[20:21]
s_cmp_ge_u32 s8, 896
s_cselect_b32 s8, 0, s8
s_add_u32 s9, s8, 128
s_cmp_ge_u32 s9, 896
s_cselect_b32 s9, 0, s9
global_load_lds_dword v58, s[38:39]
s_add_u32 m0, s100, 106496
s_add_u32 s10, s9, 128
s_cmp_ge_u32 s10, 896
s_cselect_b32 s10, 0, s10
s_mov_b32 s67, 0x20000
s_mov_b32 s71, 0x20000
global_load_ushort v110, v59, s[30:31]
s_mov_b32 s75, 0x20000
s_mov_b32 s79, 0x20000
s_mov_b32 s87, 0x20000
s_mov_b32 s91, 0x20000
s_lshl_b32 s64, s51, 7
global_load_ushort v111, v60, s[32:33]
s_sub_u32 s66, 1605632, s64
s_add_u32 s64, s64, s36
s_addc_u32 s65, s37, 0
s_mul_i32 s68, s101, 28672
s_lshl_b32 s69, s12, 7
buffer_load_dwordx4 v4, s[52:55], s5 offen offset:0 lds
s_add_u32 s68, s68, s69
s_sub_u32 s70, 401408, s68
s_cmp_ge_u32 s3, 2
s_cselect_b32 s26, s28, s26
s_cselect_b32 s27, s29, s27
s_add_u32 s68, s68, s26
s_addc_u32 s69, s27, 0
s_lshl_b32 s72, s12, 3
s_add_u32 s72, s72, s3
s_mul_i32 s72, s72, 28672
s_sub_u32 s74, 1605632, s72
s_add_u32 s72, s72, s40
s_addc_u32 s73, s41, 0
buffer_load_dwordx4 v5, s[52:55], s5 offen offset:1024 lds
s_add_u32 m0, s15, 16384
s_lshl_b32 s76, s51, 12
s_add_u32 s76, s76, 4096
s_add_u32 s76, s76, s48
s_addc_u32 s77, s49, 0
s_mov_b32 s78, 4096
s_mul_i32 s84, s11, 28
s_add_u32 s84, s84, s3
s_mul_i32 s84, s84, 128
s_add_u32 s84, s84, 1048576
s_add_u32 s84, s84, s48
s_addc_u32 s85, s49, 0
s_mov_b32 s86, 3200
s_lshr_b32 s99, s3, 1
buffer_load_dwordx4 v6, s[56:59], s5 offen offset:0 lds
s_lshl_b32 s88, s11, 2
s_add_u32 s88, s88, s99
s_mul_i32 s88, s88, 28672
s_lshl_b32 s89, s101, 7
s_add_u32 s88, s88, s89
s_sub_u32 s90, 3670016, s88
s_add_u32 s88, s88, s44
s_addc_u32 s89, s45, 0
s_lshr_b32 s92, s11, 2
s_mul_i32 s51, s92, 43
s_lshr_b32 s51, s51, 8
s_mul_i32 s51, s51, 6
s_sub_u32 s51, s92, s51
buffer_load_dwordx4 v7, s[60:63], s5 offen offset:1024 lds
s_add_u32 s92, s51, s12
s_add_u32 s92, s92, 1
s_cmp_ge_u32 s92, 7
s_cselect_b32 s98, 7, 0
s_sub_u32 s92, s92, s98
s_lshl_b32 s92, s92, 7
s_add_u32 s51, s51, 1
s_cmp_ge_u32 s51, 6
s_cselect_b32 s51, 0, s51
s_add_u32 s93, s51, s12
s_add_u32 s93, s93, 1
s_cmp_ge_u32 s93, 7
s_cselect_b32 s98, 7, 0
s_sub_u32 s93, s93, s98
s_lshl_b32 s93, s93, 7
s_add_u32 s51, s51, 1
s_cmp_ge_u32 s51, 6
s_cselect_b32 s51, 0, s51
s_add_u32 s94, s51, s12
s_add_u32 s94, s94, 1
s_cmp_ge_u32 s94, 7
s_cselect_b32 s98, 7, 0
s_sub_u32 s94, s94, s98
s_lshl_b32 s94, s94, 7
s_add_u32 s51, s51, 1
s_cmp_ge_u32 s51, 6
s_cselect_b32 s51, 0, s51
s_add_u32 s95, s51, s12
s_add_u32 s95, s95, 1
s_cmp_ge_u32 s95, 7
s_cselect_b32 s98, 7, 0
s_sub_u32 s95, s95, s98
s_lshl_b32 s95, s95, 7
s_add_u32 s51, s51, 1
s_cmp_ge_u32 s51, 6
s_cselect_b32 s51, 0, s51
s_add_u32 s96, s51, s12
s_add_u32 s96, s96, 1
s_cmp_ge_u32 s96, 7
s_cselect_b32 s98, 7, 0
s_sub_u32 s96, s96, s98
s_lshl_b32 s96, s96, 7
s_add_u32 s51, s51, 1
s_cmp_ge_u32 s51, 6
s_cselect_b32 s51, 0, s51
s_add_u32 s97, s51, s12
s_add_u32 s97, s97, 1
s_cmp_ge_u32 s97, 7
s_cselect_b32 s98, 7, 0
s_sub_u32 s97, s97, s98
s_lshl_b32 s97, s97, 7
s_lshl_b32 s98, s12, 7
v_add_u32 v11, 27648, v10
v_add_u32 v19, 6144, v18
v_add_u32 v12, 55296, v10
v_add_u32 v20, 12288, v18
v_add_u32 v13, 82944, v10
v_add_u32 v21, 18432, v18
v_mov_b32 v14, v6
v_add_u32 v15, 6144, v7
v_add_u32 v16, 12288, v6
v_add_u32 v17, 18432, v7
v_lshrrev_b32 v57, 1, v2
v_xor_b32 v57, v57, v3
v_and_b32 v57, 7, v57
v_lshlrev_b32 v57, 4, v57
v_lshl_add_u32 v57, v2, 7, v57
v_xor_b32 v58, 0, v57
v_add_u32 v22, 98304, v58
v_add_u32 v26, s15, v58
v_add_u32 v30, 0x10000, v26
v_xor_b32 v58, 32, v57
v_add_u32 v23, 98304, v58
v_add_u32 v27, s15, v58
v_add_u32 v31, 0x10000, v27
v_xor_b32 v58, 64, v57
v_add_u32 v24, 98304, v58
v_add_u32 v28, s15, v58
v_add_u32 v32, 0x10000, v28
v_xor_b32 v58, 96, v57
v_add_u32 v25, 98304, v58
v_add_u32 v29, s15, v58
v_add_u32 v33, 0x10000, v29
s_lshl_b32 s51, s3, 5
v_xor_b32 v34, s51, v22
s_add_u32 s50, s50, 157696
v_lshl_add_u32 v39, v3, 4, s50
v_lshl_add_u32 v40, v3, 5, s50
s_sub_u32 s50, s12, s13
s_cselect_b32 s51, 7, 0
s_add_u32 s50, s50, s51
s_lshl_b32 s50, s50, 1
s_add_u32 s50, s50, s99
s_lshl_b32 s50, s50, 12
s_lshl_b32 s51, s101, 6
v_xor_b32 v41, s51, v22
v_add_u32 v41, s50, v41
v_xor_b32 v42, 32, v41
v_bfe_u32 v57, v1, 2, 2
v_lshl_add_u32 v57, v3, 3, v57
v_lshlrev_b32 v57, 7, v57
v_bfe_u32 v58, v1, 3, 1
v_lshl_add_u32 v57, v58, 6, v57
v_and_b32 v58, 1, v1
v_lshl_add_u32 v57, v58, 5, v57
v_and_b32 v58, 16, v1
v_add_u32 v57, v57, v58
v_and_b32 v58, 2, v1
v_lshl_add_u32 v57, v58, 2, v57
v_add_u32 v35, s15, v57
v_xor_b32 v36, 64, v35
v_add_u32 v37, 0x10000, v35
v_add_u32 v38, 0x10000, v36
v_lshlrev_b32 v0, 4, v1
s_add_u32 s51, s15, 114688
v_add_u32 v142, s51, v0
v_lshl_add_u32 v141, v2, 2, s51
v_lshl_add_u32 v141, v3, 11, v141
s_lshl_b32 s51, s99, 14
s_add_u32 s51, s51, 114688
v_add_u32 v143, s51, v0
v_bfe_u32 v57, v1, 2, 2
v_lshl_add_u32 v58, v3, 3, v57
v_lshlrev_b32 v58, 7, v58
v_and_b32 v59, 1, v1
v_lshl_add_u32 v58, v59, 6, v58
v_and_b32 v59, 2, v1
v_lshl_add_u32 v58, v59, 2, v58
v_lshlrev_b32 v59, 4, v57
v_and_b32 v60, 16, v1
v_xor_b32 v59, v59, v60
s_lshl_b32 s51, s99, 5
v_xor_b32 v59, s51, v59
v_add_u32 v58, v58, v59
v_add_u32 v136, 98304, v58
v_lshl_add_u32 v57, v3, 4, v57
v_lshlrev_b32 v57, 7, v57
v_bfe_u32 v58, v1, 3, 1
v_xor_b32 v58, s101, v58
v_lshl_add_u32 v57, v58, 6, v57
v_lshl_add_u32 v57, v60, 1, v57
v_and_b32 v58, 3, v1
v_lshl_add_u32 v139, v58, 3, v57
v_lshlrev_b32 v57, 4, v58
v_lshl_add_u32 v57, v2, 7, v57
v_lshl_add_u32 v57, v3, 6, v57
s_add_u32 s51, s15, 98304
v_add_u32 v138, s51, v57
v_bfe_u32 v57, v2, 2, 1
v_lshrrev_b32 v59, 3, v2
v_lshl_add_u32 v57, v57, 3, v59
v_lshl_add_u32 v57, v57, 2, v58
v_lshlrev_b32 v57, 2, v57
v_add_u32 v137, 156672, v57
v_bfe_u32 v57, v2, 1, 3
v_lshlrev_b32 v57, 4, v57
v_lshl_add_u32 v57, v2, 7, v57
v_lshl_add_u32 v57, v3, 13, v57
v_lshl_add_u32 v140, s101, 12, v57
s_mov_b32 s99, 0
buffer_load_dwordx4 v8, s[56:59], s5 offen offset:2048 lds
buffer_load_dwordx4 v9, s[60:63], s5 offen offset:3072 lds
s_waitcnt lgkmcnt(0)
s_add_u32 s14, s14, 2654435769
s_mov_b32 s34, 0x3fb8aa3b
s_mov_b32 s36, 0x3f3504f3
s_waitcnt vmcnt(12)
s_barrier
ds_read_b128 v[112:115], v26 offset:0
ds_read_b128 a[0:3], v22 offset:0
ds_read_b128 a[4:7], v22 offset:4096
ds_read_b128 v[116:119], v27 offset:0
ds_read_b128 a[8:11], v23 offset:0
ds_read_b128 a[12:15], v23 offset:4096
s_waitcnt lgkmcnt(4)
v_mfma_f32_32x32x16_bf16 v[144:159], a[0:3], v[112:115], 0
s_add_u32 m0, s100, 114688
s_nop 0
buffer_load_dwordx4 v4, s[52:55], s6 offen offset:0 lds
buffer_load_dwordx4 v5, s[52:55], s6 offen offset:1024 lds
s_add_u32 m0, s15, 32768
s_nop 0
buffer_load_dwordx4 v6, s[56:59], s6 offen offset:0 lds
buffer_load_dwordx4 v7, s[60:63], s6 offen offset:1024 lds
buffer_load_dwordx4 v8, s[56:59], s6 offen offset:2048 lds
buffer_load_dwordx4 v9, s[60:63], s6 offen offset:3072 lds
s_add_u32 m0, s100, 122880
s_nop 0
buffer_load_dwordx4 v4, s[52:55], s7 offen offset:0 lds
ds_read_b128 v[120:123], v28 offset:0
ds_read_b128 a[16:19], v24 offset:0
s_waitcnt lgkmcnt(5)
v_mfma_f32_32x32x16_bf16 v[160:175], a[4:7], v[112:115], 0
buffer_load_dwordx4 v5, s[52:55], s7 offen offset:1024 lds
s_add_u32 m0, s15, 49152
ds_read_b128 a[20:23], v24 offset:4096
s_waitcnt lgkmcnt(3)
v_mfma_f32_32x32x16_bf16 v[144:159], a[8:11], v[116:119], v[144:159]
buffer_load_dwordx4 v6, s[56:59], s7 offen offset:0 lds
ds_read_b128 v[124:127], v29 offset:0
ds_read_b128 a[24:27], v25 offset:0
v_mfma_f32_32x32x16_bf16 v[160:175], a[12:15], v[116:119], v[160:175]
buffer_load_dwordx4 v7, s[60:63], s7 offen offset:1024 lds
ds_read_b128 a[28:31], v25 offset:4096
s_waitcnt lgkmcnt(3)
v_mfma_f32_32x32x16_bf16 v[144:159], a[16:19], v[120:123], v[144:159]
v_mov_b32 v104, 0
v_mov_b32 v105, 0
v_mov_b32 v106, 0
v_mov_b32 v107, 0
s_waitcnt vmcnt(18)
s_mov_b32 exec_lo, 0x10100101
s_mov_b32 exec_hi, 0x10100101
ds_read_b128 v[104:107], v39 offset:0
s_mov_b64 exec, -1
ds_read_b128 v[96:99], v34 offset:0
v_mfma_f32_32x32x16_bf16 v[160:175], a[20:23], v[120:123], v[160:175]
buffer_load_dwordx4 v8, s[56:59], s7 offen offset:2048 lds
ds_read_b128 v[100:103], v34 offset:4096
s_getreg_b32 s83, hwreg(HW_REG_XCC_ID, 0, 4)
s_lshl2_add_u32 s80, s12, 0
s_waitcnt lgkmcnt(3)
v_mfma_f32_32x32x16_bf16 v[144:159], a[24:27], v[124:127], v[144:159]
s_waitcnt vmcnt(11)
s_barrier
ds_read_b128 v[112:115], v26 offset:16384
ds_read_b128 a[32:35], v22 offset:8192
s_add_u32 s83, s83, s14
v_mfma_f32_32x32x16_bf16 v[160:175], a[28:31], v[124:127], v[160:175]
buffer_load_dwordx4 v9, s[60:63], s7 offen offset:3072 lds
s_add_u32 m0, s100, 131072
ds_read_b128 a[36:39], v22 offset:12288
v_mov_b32 v208, s83
s_waitcnt lgkmcnt(3)
v_mfma_f32_16x16x32_bf16 a[224:227], v[104:107], v[96:99], 0
buffer_load_dwordx4 v4, s[52:55], s8 offen offset:0 lds
ds_read_b128 v[116:119], v27 offset:16384
ds_read_b128 a[40:43], v23 offset:8192
v_mfma_f32_16x16x32_bf16 a[240:243], v[104:107], v[100:103], 0
ds_read_b128 a[44:47], v23 offset:12288
buffer_load_dwordx4 v5, s[52:55], s8 offen offset:1024 lds
s_add_u32 m0, s15, 65536
s_waitcnt lgkmcnt(3)
v_mfma_f32_32x32x16_bf16 v[144:159], a[32:35], v[112:115], v[144:159]
ds_read_b128 v[120:123], v28 offset:16384
ds_read_b128 a[48:51], v24 offset:8192
ds_read_b128 a[52:55], v24 offset:12288
ds_read_b128 v[124:127], v29 offset:16384
v_mfma_f32_32x32x16_bf16 v[160:175], a[36:39], v[112:115], v[160:175]
buffer_load_dwordx4 v6, s[56:59], s8 offen offset:0 lds
ds_read_b128 a[56:59], v25 offset:8192
ds_read_b128 a[60:63], v25 offset:12288
s_waitcnt lgkmcnt(6)
v_mfma_f32_32x32x16_bf16 v[144:159], a[40:43], v[116:119], v[144:159]
buffer_load_dwordx4 v7, s[60:63], s8 offen offset:1024 lds
s_mov_b32 exec_lo, 0x10100101
s_mov_b32 exec_hi, 0x10100101
ds_read_b128 v[104:107], v39 offset:32
s_mov_b64 exec, -1
v_mfma_f32_32x32x16_bf16 v[160:175], a[44:47], v[116:119], v[160:175]
ds_read_b128 v[96:99], v34 offset:8192
ds_read_b128 v[100:103], v34 offset:12288
s_waitcnt lgkmcnt(3)
v_mfma_f32_32x32x16_bf16 v[144:159], a[48:51], v[120:123], v[144:159]
buffer_load_dwordx4 v8, s[56:59], s8 offen offset:2048 lds
buffer_store_dword v208, off, s[84:87], s80 sc1
v_lshlrev_b32 v110, 16, v110
v_mfma_f32_32x32x16_bf16 v[160:175], a[52:55], v[120:123], v[160:175]
v_mul_f32 v110, 0x3fb8aa3b, v110
v_exp_f32 v110, v110
v_lshlrev_b32 v108, 16, v108
v_lshlrev_b32 v109, 16, v109
v_cvt_pk_bf16_f32 v110, v110, v110
v_lshlrev_b32 v208, 28, v1
v_mfma_f32_32x32x16_bf16 v[144:159], a[56:59], v[124:127], v[144:159]
s_waitcnt vmcnt(12)
s_barrier
ds_read_b128 v[112:115], v26 offset:32768
ds_read_b128 a[64:67], v22 offset:16384
v_and_b32 v208, 0x80000000, v208
v_mfma_f32_32x32x16_bf16 v[160:175], a[60:63], v[124:127], v[160:175]
buffer_load_dwordx4 v9, s[60:63], s8 offen offset:3072 lds
s_add_u32 m0, s100, 139264
ds_read_b128 a[68:71], v22 offset:20480
v_lshlrev_b32 v110, 16, v110
s_waitcnt lgkmcnt(3)
v_mfma_f32_16x16x32_bf16 a[224:227], v[104:107], v[96:99], a[224:227]
buffer_load_dwordx4 v4, s[52:55], s9 offen offset:0 lds
ds_read_b128 v[116:119], v27 offset:32768
ds_read_b128 a[72:75], v23 offset:16384
v_xor_b32 v109, v208, v109
v_mfma_f32_16x16x32_bf16 a[240:243], v[104:107], v[100:103], a[240:243]
ds_read_b128 a[76:79], v23 offset:20480
buffer_load_dwordx4 v5, s[52:55], s9 offen offset:1024 lds
s_add_u32 m0, s15, 81920
v_xor_b32 v109, 0x80000000, v109
s_waitcnt lgkmcnt(3)
v_mfma_f32_32x32x16_bf16 v[144:159], a[64:67], v[112:115], v[144:159]
ds_read_b128 v[120:123], v28 offset:32768
ds_read_b128 a[80:83], v24 offset:16384
ds_read_b128 a[84:87], v24 offset:20480
ds_read_b128 v[124:127], v29 offset:32768
v_mfma_f32_32x32x16_bf16 v[160:175], a[68:71], v[112:115], v[160:175]
buffer_load_dwordx4 v6, s[56:59], s9 offen offset:0 lds
ds_read_b128 a[88:91], v25 offset:16384
ds_read_b128 a[92:95], v25 offset:20480
s_waitcnt lgkmcnt(6)
v_mfma_f32_32x32x16_bf16 v[144:159], a[72:75], v[116:119], v[144:159]
buffer_load_dwordx4 v7, s[60:63], s9 offen offset:1024 lds
s_mov_b32 exec_lo, 0x10100101
s_mov_b32 exec_hi, 0x10100101
ds_read_b128 v[104:107], v39 offset:64
s_mov_b64 exec, -1
v_mfma_f32_32x32x16_bf16 v[160:175], a[76:79], v[116:119], v[160:175]
ds_read_b128 v[96:99], v34 offset:16384
ds_read_b128 v[100:103], v34 offset:20480
v_xor_b32 v208, 2.0, v208
v_mul_f32 v209, v110, v108
v_mul_f32 v210, v110, v109
s_waitcnt lgkmcnt(3)
v_mfma_f32_32x32x16_bf16 v[144:159], a[80:83], v[120:123], v[144:159]
buffer_load_dwordx4 v8, s[56:59], s9 offen offset:2048 lds
v_mul_f32 v209, 0x3fb8aa3b, v209
v_mul_f32 v210, 0.15915494, v210
v_exp_f32 v209, v209
v_rndne_f32 v211, v210
v_mfma_f32_32x32x16_bf16 v[160:175], a[84:87], v[120:123], v[160:175]
v_sub_f32 v210, v210, v211
v_cos_f32 v211, v210
v_sin_f32 v212, v210
v_mul_f32 v213, v108, v108
v_fmac_f32 v213, v109, v109
v_mfma_f32_32x32x16_bf16 v[144:159], a[88:91], v[124:127], v[144:159]
s_waitcnt vmcnt(12)
s_barrier
ds_read_b128 v[112:115], v26 offset:49152
ds_read_b128 a[96:99], v22 offset:24576
v_mfma_f32_32x32x16_bf16 v[160:175], a[92:95], v[124:127], v[160:175]
buffer_load_dwordx4 v9, s[60:63], s9 offen offset:3072 lds
s_add_u32 m0, s100, 147456
ds_read_b128 a[100:103], v22 offset:28672
s_waitcnt lgkmcnt(3)
v_mfma_f32_16x16x32_bf16 a[224:227], v[104:107], v[96:99], a[224:227]
buffer_load_dwordx4 v4, s[52:55], s10 offen offset:0 lds
ds_read_b128 v[116:119], v27 offset:49152
ds_read_b128 a[104:107], v23 offset:24576
ds_read_b128 a[108:111], v23 offset:28672
ds_read_b128 v[120:123], v28 offset:49152
ds_read_b128 a[112:115], v24 offset:24576
v_rcp_f32 v213, v213
v_mul_f32 v43, v211, v209
v_mul_f32 v44, v212, v209
v_mfma_f32_16x16x32_bf16 a[240:243], v[104:107], v[100:103], a[240:243]
buffer_load_dwordx4 v5, s[52:55], s10 offen offset:1024 lds
s_add_u32 m0, s15, 0
ds_read_b128 a[116:119], v24 offset:28672
v_mul_f32 v213, v213, v208
v_add_f32 v209, -1.0, v43
v_mul_f32 v210, v209, v108
v_fmac_f32 v210, v44, v109
v_mul_f32 v55, v210, v213
v_mul_f32 v210, v44, v108
v_fma_f32 v210, -v209, v109, v210
v_mul_f32 v56, v210, v213
v_mul_f32 v214, v44, v44
v_add_f32 v213, v43, v43
s_waitcnt lgkmcnt(6)
v_mfma_f32_32x32x16_bf16 v[144:159], a[96:99], v[112:115], v[144:159]
ds_read_b128 v[124:127], v29 offset:49152
ds_read_b128 a[120:123], v25 offset:24576
v_fma_f32 v208, v43, v43, -v214
v_mul_f32 v209, v213, v44
v_mul_f32 v214, v209, v209
v_add_f32 v213, v208, v208
v_fma_f32 v208, v208, v208, -v214
v_mul_f32 v209, v213, v209
v_mul_f32 v214, v209, v209
v_add_f32 v213, v208, v208
v_fma_f32 v208, v208, v208, -v214
v_mul_f32 v209, v213, v209
v_mul_f32 v214, v209, v209
v_add_f32 v213, v208, v208
v_fma_f32 v45, v208, v208, -v214
v_mfma_f32_32x32x16_bf16 v[160:175], a[100:103], v[112:115], v[160:175]
buffer_load_dwordx4 v6, s[56:59], s10 offen offset:0 lds
ds_read_b128 a[124:127], v25 offset:28672
v_mul_f32 v46, v213, v209
v_mul_f32 v214, v46, v46
v_add_f32 v213, v45, v45
v_fma_f32 v47, v45, v45, -v214
v_mul_f32 v48, v213, v46
v_mul_f32 v214, v48, v48
v_add_f32 v213, v47, v47
v_fma_f32 v49, v47, v47, -v214
v_mul_f32 v50, v213, v48
v_mul_f32 v214, v50, v50
v_add_f32 v213, v49, v49
s_waitcnt lgkmcnt(3)
v_mfma_f32_32x32x16_bf16 v[144:159], a[104:107], v[116:119], v[144:159]
buffer_load_dwordx4 v7, s[60:63], s10 offen offset:1024 lds
s_mov_b32 exec_lo, 0x10100101
s_mov_b32 exec_hi, 0x10100101
ds_read_b128 v[104:107], v39 offset:96
s_mov_b64 exec, -1
ds_read_b128 v[96:99], v34 offset:24576
v_fma_f32 v208, v49, v49, -v214
v_mul_f32 v209, v213, v50
v_mul_f32 v214, v209, v209
v_add_f32 v213, v208, v208
v_fma_f32 v208, v208, v208, -v214
v_mul_f32 v209, v213, v209
v_mul_f32 v214, v209, v209
v_mfma_f32_32x32x16_bf16 v[160:175], a[108:111], v[116:119], v[160:175]
ds_read_b128 v[100:103], v34 offset:28672
v_add_f32 v213, v208, v208
v_fma_f32 v51, v208, v208, -v214
v_mul_f32 v52, v213, v209
v_mul_f32 v214, v52, v52
v_add_f32 v213, v51, v51
v_fma_f32 v53, v51, v51, -v214
v_mul_f32 v54, v213, v52
v_and_b32 v208, 1, v1
v_lshlrev_b32 v208, 4, v208
v_lshlrev_b32 v208, v208, v111
v_bfe_u32 v209, v1, 1, 2
v_bfe_u32 v210, v1, 4, 1
v_lshl_add_u32 v209, v210, 2, v209
v_bfe_u32 v210, v1, 3, 1
v_xor_b32 v210, v210, v3
v_mfma_f32_32x32x16_bf16 v[144:159], a[112:115], v[120:123], v[144:159]
buffer_load_dwordx4 v8, s[56:59], s10 offen offset:2048 lds
v_lshl_add_u32 v209, v210, 3, v209
ds_read_b128 v[240:243], v40 offset:256
ds_read_b128 v[244:247], v40 offset:272
ds_read_b128 v[248:251], v40 offset:320
ds_read_b128 v[252:255], v40 offset:336
v_cmp_eq_u32 vcc, 0, v209
s_waitcnt lgkmcnt(3)
v_lshlrev_b32 v192, 16, v240
v_and_b32 v193, 0xffff0000, v240
v_cndmask_b32 v80, 0, v208
v_mfma_f32_32x32x16_bf16 v[160:175], a[116:119], v[120:123], v[160:175]
v_lshlrev_b32 v194, 16, v241
v_and_b32 v195, 0xffff0000, v241
v_cmp_eq_u32 vcc, 1, v209
v_lshlrev_b32 v196, 16, v242
v_and_b32 v197, 0xffff0000, v242
v_cndmask_b32 v81, 0, v208
v_lshlrev_b32 v198, 16, v243
v_and_b32 v199, 0xffff0000, v243
v_cmp_eq_u32 vcc, 2, v209
s_waitcnt lgkmcnt(2)
v_lshlrev_b32 v200, 16, v244
v_and_b32 v201, 0xffff0000, v244
v_cndmask_b32 v82, 0, v208
v_lshlrev_b32 v202, 16, v245
v_and_b32 v203, 0xffff0000, v245
v_cmp_eq_u32 vcc, 3, v209
v_mfma_f32_32x32x16_bf16 v[144:159], a[120:123], v[124:127], v[144:159]
s_waitcnt vmcnt(11)
s_barrier
ds_read_b128 v[112:115], v30 offset:0
ds_read_b128 a[128:131], v22 offset:32768
v_lshlrev_b32 v204, 16, v246
v_mfma_f32_32x32x16_bf16 v[160:175], a[124:127], v[124:127], v[160:175]
buffer_load_dwordx4 v9, s[60:63], s10 offen offset:3072 lds
s_add_u32 m0, s15, 16384
s_mul_i32 s100, s4, 1792
ds_read_b128 a[132:135], v22 offset:36864
v_and_b32 v205, 0xffff0000, v246
v_mfma_f32_16x16x32_bf16 a[224:227], v[104:107], v[96:99], a[224:227]
buffer_load_dwordx4 v10, s[64:67], s100 offen offset:0 lds
ds_read_b128 v[116:119], v31 offset:0
ds_read_b128 a[136:139], v23 offset:32768
v_cndmask_b32 v83, 0, v208
v_mfma_f32_16x16x32_bf16 a[240:243], v[104:107], v[100:103], a[240:243]
ds_read_b128 a[140:143], v23 offset:36864
buffer_load_dwordx4 v11, s[64:67], s100 offen offset:1024 lds
ds_read_b128 v[120:123], v32 offset:0
s_waitcnt lgkmcnt(4)
v_mfma_f32_32x32x16_bf16 v[144:159], a[128:131], v[112:115], v[144:159]
ds_read_b128 a[144:147], v24 offset:32768
ds_read_b128 a[148:151], v24 offset:36864
ds_read_b128 v[124:127], v33 offset:0
ds_read_b128 a[152:155], v25 offset:32768
v_mfma_f32_32x32x16_bf16 v[160:175], a[132:135], v[112:115], v[160:175]
buffer_load_dwordx4 v12, s[64:67], s100 offen offset:2048 lds
ds_read_b128 a[156:159], v25 offset:36864
v_lshlrev_b32 v206, 16, v247
v_and_b32 v207, 0xffff0000, v247
s_waitcnt lgkmcnt(5)
v_mfma_f32_32x32x16_bf16 v[144:159], a[136:139], v[116:119], v[144:159]
buffer_load_dwordx4 v13, s[64:67], s100 offen offset:3072 lds
s_add_u32 m0, s15, 32768
s_add_u32 s100, s100, 114688
v_cmp_eq_u32 vcc, 4, v209
v_lshlrev_b32 v224, 16, v248
v_and_b32 v225, 0xffff0000, v248
v_mfma_f32_32x32x16_bf16 v[160:175], a[140:143], v[116:119], v[160:175]
s_mov_b32 exec_lo, 0x10100101
s_mov_b32 exec_hi, 0x10100101
ds_read_b128 v[104:107], v39 offset:128
s_mov_b64 exec, -1
ds_read_b128 v[96:99], v34 offset:32768
s_waitcnt lgkmcnt(2)
v_mfma_f32_32x32x16_bf16 v[144:159], a[144:147], v[120:123], v[144:159]
buffer_load_dwordx4 v10, s[64:67], s100 offen offset:0 lds
ds_read_b128 v[100:103], v34 offset:36864
v_cndmask_b32 v84, 0, v208
v_lshlrev_b32 v226, 16, v249
v_and_b32 v227, 0xffff0000, v249
v_mfma_f32_32x32x16_bf16 v[160:175], a[148:151], v[120:123], v[160:175]
v_cmp_eq_u32 vcc, 5, v209
v_lshlrev_b32 v228, 16, v250
v_and_b32 v229, 0xffff0000, v250
v_cndmask_b32 v85, 0, v208
v_lshlrev_b32 v230, 16, v251
v_and_b32 v231, 0xffff0000, v251
v_cmp_eq_u32 vcc, 6, v209
v_mfma_f32_32x32x16_bf16 v[144:159], a[152:155], v[124:127], v[144:159]
s_waitcnt vmcnt(11)
s_barrier
ds_read_b128 v[112:115], v30 offset:16384
ds_read_b128 a[160:163], v22 offset:40960
v_lshlrev_b32 v232, 16, v252
v_mfma_f32_32x32x16_bf16 v[160:175], a[156:159], v[124:127], v[160:175]
buffer_load_dwordx4 v11, s[64:67], s100 offen offset:1024 lds
ds_read_b128 a[164:167], v22 offset:45056
ds_read_b128 v[116:119], v31 offset:16384
s_waitcnt lgkmcnt(4)
v_mfma_f32_16x16x32_bf16 a[224:227], v[104:107], v[96:99], a[224:227]
buffer_load_dwordx4 v12, s[64:67], s100 offen offset:2048 lds
ds_read_b128 a[168:171], v23 offset:40960
ds_read_b128 a[172:175], v23 offset:45056
v_and_b32 v233, 0xffff0000, v252
v_mfma_f32_16x16x32_bf16 a[240:243], v[104:107], v[100:103], a[240:243]
buffer_load_dwordx4 v13, s[64:67], s100 offen offset:3072 lds
s_add_u32 m0, s15, 49152
s_mul_i32 s100, s5, 1792
v_cndmask_b32 v86, 0, v208
v_lshlrev_b32 v234, 16, v253
s_waitcnt lgkmcnt(2)
v_mfma_f32_32x32x16_bf16 v[144:159], a[160:163], v[112:115], v[144:159]
s_mov_b32 exec_lo, 0x10100101
s_mov_b32 exec_hi, 0x10100101
ds_read_b128 v[104:107], v39 offset:160
s_mov_b64 exec, -1
ds_read_b128 v[96:99], v34 offset:40960
v_and_b32 v235, 0xffff0000, v253
v_mfma_f32_32x32x16_bf16 v[160:175], a[164:167], v[112:115], v[160:175]
ds_read_b128 v[100:103], v34 offset:45056
buffer_load_dwordx4 v10, s[64:67], s100 offen offset:0 lds
ds_read_b128 v[120:123], v32 offset:16384
s_waitcnt lgkmcnt(4)
v_mfma_f32_32x32x16_bf16 v[144:159], a[168:171], v[116:119], v[144:159]
ds_read_b128 a[176:179], v24 offset:40960
buffer_load_dwordx4 v11, s[64:67], s100 offen offset:1024 lds
ds_read_b128 a[180:183], v24 offset:45056
v_cmp_eq_u32 vcc, 7, v209
v_mfma_f32_32x32x16_bf16 v[160:175], a[172:175], v[116:119], v[160:175]
ds_read_b128 v[124:127], v33 offset:16384
ds_read_b128 a[184:187], v25 offset:40960
ds_read_b128 a[188:191], v25 offset:45056
v_lshlrev_b32 v236, 16, v254
s_waitcnt lgkmcnt(5)
v_mfma_f32_16x16x32_bf16 a[224:227], v[104:107], v[96:99], a[224:227]
buffer_load_dwordx4 v12, s[64:67], s100 offen offset:2048 lds
v_and_b32 v237, 0xffff0000, v254
v_cndmask_b32 v87, 0, v208
v_lshlrev_b32 v238, 16, v255
v_and_b32 v239, 0xffff0000, v255
s_lshl2_add_u32 s50, s3, 155648
v_mfma_f32_16x16x32_bf16 a[240:243], v[104:107], v[100:103], a[240:243]
v_lshl_add_u32 v108, v2, 4, s50
s_waitcnt lgkmcnt(0)
v_mfma_f32_32x32x16_bf16 v[144:159], a[176:179], v[120:123], v[144:159]
s_waitcnt vmcnt(11)
s_barrier
s_mov_b32 exec_lo, 0x10100101
s_mov_b32 exec_hi, 0x10100101
ds_read_b128 v[104:107], v39 offset:192
s_mov_b64 exec, -1
ds_read_b128 v[96:99], v34 offset:49152
v_mfma_f32_32x32x16_bf16 v[160:175], a[180:183], v[120:123], v[160:175]
buffer_load_dwordx4 v13, s[64:67], s100 offen offset:3072 lds
s_add_u32 m0, s15, 65536
s_add_u32 s100, s100, 114688
ds_read_b128 v[100:103], v34 offset:53248
v_mfma_f32_32x32x16_bf16 v[144:159], a[184:187], v[124:127], v[144:159]
ds_read_b128 v[88:91], v41
buffer_load_dwordx4 v10, s[64:67], s100 offen offset:0 lds
ds_read_b128 v[92:95], v42
v_mfma_f32_32x32x16_bf16 v[160:175], a[188:191], v[124:127], v[160:175]
ds_read_b128 v[112:115], v26 offset:0
ds_read_b128 a[192:195], v22 offset:49152
ds_read_b128 a[196:199], v22 offset:53248
s_waitcnt lgkmcnt(5)
v_mfma_f32_16x16x32_bf16 a[224:227], v[104:107], v[96:99], a[224:227]
ds_read_b128 v[116:119], v27 offset:0
ds_read_b128 a[200:203], v23 offset:49152
v_mfma_f32_16x16x32_bf16 a[240:243], v[104:107], v[100:103], a[240:243]
buffer_load_dwordx4 v11, s[64:67], s100 offen offset:1024 lds
ds_read_b128 a[204:207], v23 offset:53248
s_waitcnt lgkmcnt(3)
v_mfma_f32_32x32x16_bf16 v[64:79], v[88:91], v[80:83], 0
s_nop 4
ds_write_b32 v108, a224
ds_read_b128 v[120:123], v28 offset:0
ds_read_b128 a[208:211], v24 offset:49152
v_mfma_f32_32x32x16_bf16 v[64:79], v[92:95], v[84:87], v[64:79]
ds_write_b32 v108, a240 offset:512
ds_read_b128 a[212:215], v24 offset:53248
v_mfma_f32_32x32x16_bf16 v[144:159], a[192:195], v[112:115], v[144:159]
s_waitcnt lgkmcnt(1)
s_barrier
buffer_load_dwordx4 v12, s[64:67], s100 offen offset:2048 lds
ds_read_b128 v[124:127], v29 offset:0
v_mfma_f32_32x32x16_bf16 v[160:175], a[196:199], v[112:115], v[160:175]
ds_read_b128 a[216:219], v25 offset:49152
ds_read_b128 a[220:223], v25 offset:53248
s_waitcnt lgkmcnt(3)
v_mfma_f32_32x32x16_bf16 v[144:159], a[200:203], v[116:119], v[144:159]
v_mfma_f32_32x32x16_bf16 v[160:175], a[204:207], v[116:119], v[160:175]
s_waitcnt vmcnt(11)
ds_read_b64_tr_b16 v[176:177], v35 offset:16384
buffer_load_dwordx4 v13, s[64:67], s100 offen offset:3072 lds
s_add_u32 m0, s15, 81920
s_mul_i32 s100, s6, 1792
v_mfma_f32_32x32x16_bf16 v[144:159], a[208:211], v[120:123], v[144:159]
ds_read_b64_tr_b16 v[178:179], v35 offset:16896
ds_read_b64_tr_b16 v[180:181], v36 offset:16384
ds_read_b64_tr_b16 v[182:183], v36 offset:16896
v_mfma_f32_32x32x16_bf16 v[160:175], a[212:215], v[120:123], v[160:175]
buffer_load_dwordx4 v10, s[64:67], s100 offen offset:0 lds
ds_read_b64_tr_b16 v[184:185], v35 offset:18432
s_waitcnt lgkmcnt(4)
v_mfma_f32_32x32x16_bf16 v[144:159], a[216:219], v[124:127], v[144:159]
ds_read_b64_tr_b16 v[186:187], v35 offset:18944
v_mfma_f32_32x32x16_bf16 v[160:175], a[220:223], v[124:127], v[160:175]
buffer_load_dwordx4 v11, s[64:67], s100 offen offset:1024 lds
ds_read_b64_tr_b16 v[188:189], v36 offset:18432
s_waitcnt lgkmcnt(3)
v_mfma_f32_32x32x16_bf16 v[208:223], v[176:179], a[4:7], v[192:207]
ds_read_b64_tr_b16 v[190:191], v36 offset:18944
v_mfma_f32_32x32x16_bf16 v[192:207], v[176:179], a[0:3], v[192:207]
buffer_load_dwordx4 v12, s[64:67], s100 offen offset:2048 lds
v_fma_f32 v58, v43, v144, v145
v_fma_f32 v60, v43, v160, v161
v_fmac_f32_dpp v58, v144, v44 row_ror:8 row_mask:0xf bank_mask:0xf
v_fmac_f32_dpp v60, v160, v44 row_ror:8 row_mask:0xf bank_mask:0xf
v_fma_f32 v57, v43, v58, v146
v_fma_f32 v59, v43, v60, v162
v_mfma_f32_32x32x16_bf16 v[240:255], v[180:183], a[4:7], v[224:239]
v_fmac_f32_dpp v57, v58, v44 row_ror:8 row_mask:0xf bank_mask:0xf
v_fmac_f32_dpp v59, v60, v44 row_ror:8 row_mask:0xf bank_mask:0xf
v_fma_f32 v58, v43, v57, v147
v_fma_f32 v60, v43, v59, v163
v_fmac_f32_dpp v58, v57, v44 row_ror:8 row_mask:0xf bank_mask:0xf
v_fmac_f32_dpp v60, v59, v44 row_ror:8 row_mask:0xf bank_mask:0xf
v_fma_f32 v57, v43, v58, v148
v_fma_f32 v59, v43, v60, v164
v_mfma_f32_32x32x16_bf16 v[224:239], v[180:183], a[0:3], v[224:239]
s_waitcnt vmcnt(11)
ds_read_b64_tr_b16 v[176:177], v35 offset:32768
buffer_load_dwordx4 v13, s[64:67], s100 offen offset:3072 lds
s_add_u32 m0, s15, 0
s_add_u32 s100, s100, 114688
s_waitcnt lgkmcnt(1)
v_mfma_f32_32x32x16_bf16 v[208:223], v[184:187], a[12:15], v[208:223]
ds_read_b64_tr_b16 v[178:179], v35 offset:33280
ds_read_b64_tr_b16 v[180:181], v36 offset:32768
ds_read_b64_tr_b16 v[182:183], v36 offset:33280
v_fmac_f32_dpp v57, v58, v44 row_ror:8 row_mask:0xf bank_mask:0xf
v_fmac_f32_dpp v59, v60, v44 row_ror:8 row_mask:0xf bank_mask:0xf
v_fma_f32 v58, v43, v57, v149
v_mfma_f32_32x32x16_bf16 v[192:207], v[184:187], a[8:11], v[192:207]
buffer_load_dwordx4 v10, s[64:67], s100 offen offset:0 lds
v_fma_f32 v60, v43, v59, v165
v_fmac_f32_dpp v58, v57, v44 row_ror:8 row_mask:0xf bank_mask:0xf
v_fmac_f32_dpp v60, v59, v44 row_ror:8 row_mask:0xf bank_mask:0xf
v_fma_f32 v57, v43, v58, v150
v_fma_f32 v59, v43, v60, v166
v_fmac_f32_dpp v57, v58, v44 row_ror:8 row_mask:0xf bank_mask:0xf
v_mfma_f32_32x32x16_bf16 v[240:255], v[188:191], a[12:15], v[240:255]
ds_read_b64_tr_b16 v[184:185], v35 offset:34816
ds_read_b64_tr_b16 v[186:187], v35 offset:35328
v_fmac_f32_dpp v59, v60, v44 row_ror:8 row_mask:0xf bank_mask:0xf
v_fma_f32 v58, v43, v57, v151
v_fma_f32 v60, v43, v59, v167
v_fmac_f32_dpp v58, v57, v44 row_ror:8 row_mask:0xf bank_mask:0xf
v_fmac_f32_dpp v60, v59, v44 row_ror:8 row_mask:0xf bank_mask:0xf
v_mfma_f32_32x32x16_bf16 v[224:239], v[188:191], a[8:11], v[224:239]
buffer_load_dwordx4 v11, s[64:67], s100 offen offset:1024 lds
v_fma_f32 v57, v43, v58, v152
v_fma_f32 v59, v43, v60, v168
v_fmac_f32_dpp v57, v58, v44 row_ror:8 row_mask:0xf bank_mask:0xf
v_fmac_f32_dpp v59, v60, v44 row_ror:8 row_mask:0xf bank_mask:0xf
v_fma_f32 v58, v43, v57, v153
s_waitcnt lgkmcnt(2)
v_mfma_f32_32x32x16_bf16 v[208:223], v[176:179], a[20:23], v[208:223]
ds_read_b64_tr_b16 v[188:189], v36 offset:34816
ds_read_b64_tr_b16 v[190:191], v36 offset:35328
v_fma_f32 v60, v43, v59, v169
v_fmac_f32_dpp v58, v57, v44 row_ror:8 row_mask:0xf bank_mask:0xf
v_fmac_f32_dpp v60, v59, v44 row_ror:8 row_mask:0xf bank_mask:0xf
v_fma_f32 v57, v43, v58, v154
v_fma_f32 v59, v43, v60, v170
v_mfma_f32_32x32x16_bf16 v[192:207], v[176:179], a[16:19], v[192:207]
buffer_load_dwordx4 v12, s[64:67], s100 offen offset:2048 lds
v_fmac_f32_dpp v57, v58, v44 row_ror:8 row_mask:0xf bank_mask:0xf
v_fmac_f32_dpp v59, v60, v44 row_ror:8 row_mask:0xf bank_mask:0xf
v_fma_f32 v58, v43, v57, v155
v_fma_f32 v60, v43, v59, v171
v_fmac_f32_dpp v58, v57, v44 row_ror:8 row_mask:0xf bank_mask:0xf
v_fmac_f32_dpp v60, v59, v44 row_ror:8 row_mask:0xf bank_mask:0xf
v_mfma_f32_32x32x16_bf16 v[240:255], v[180:183], a[20:23], v[240:255]
v_fma_f32 v57, v43, v58, v156
v_fma_f32 v59, v43, v60, v172
v_fmac_f32_dpp v57, v58, v44 row_ror:8 row_mask:0xf bank_mask:0xf
v_fmac_f32_dpp v59, v60, v44 row_ror:8 row_mask:0xf bank_mask:0xf
v_fma_f32 v58, v43, v57, v157
v_fma_f32 v60, v43, v59, v173
v_fmac_f32_dpp v58, v57, v44 row_ror:8 row_mask:0xf bank_mask:0xf
v_fmac_f32_dpp v60, v59, v44 row_ror:8 row_mask:0xf bank_mask:0xf
v_mfma_f32_32x32x16_bf16 v[224:239], v[180:183], a[16:19], v[224:239]
s_waitcnt vmcnt(11)
ds_read_b64_tr_b16 v[176:177], v35 offset:49152
buffer_load_dwordx4 v13, s[64:67], s100 offen offset:3072 lds
s_add_u32 m0, s15, 16384
s_mul_i32 s100, s7, 1792
s_waitcnt lgkmcnt(1)
v_mfma_f32_32x32x16_bf16 v[208:223], v[184:187], a[28:31], v[208:223]
ds_read_b64_tr_b16 v[178:179], v35 offset:49664
ds_read_b64_tr_b16 v[180:181], v36 offset:49152
ds_read_b64_tr_b16 v[182:183], v36 offset:49664
v_fma_f32 v57, v43, v58, v158
v_fma_f32 v59, v43, v60, v174
v_fmac_f32_dpp v57, v58, v44 row_ror:8 row_mask:0xf bank_mask:0xf
v_mfma_f32_32x32x16_bf16 v[192:207], v[184:187], a[24:27], v[192:207]
buffer_load_dwordx4 v10, s[64:67], s100 offen offset:0 lds
v_fmac_f32_dpp v59, v60, v44 row_ror:8 row_mask:0xf bank_mask:0xf
v_fma_f32 v58, v43, v57, v159
v_fma_f32 v60, v43, v59, v175
v_fmac_f32_dpp v58, v57, v44 row_ror:8 row_mask:0xf bank_mask:0xf
v_fmac_f32_dpp v60, v59, v44 row_ror:8 row_mask:0xf bank_mask:0xf
v_lshlrev_b32 v63, 4, v2
v_mfma_f32_32x32x16_bf16 v[240:255], v[188:191], a[28:31], v[240:255]
ds_read_b64_tr_b16 v[184:185], v35 offset:51200
ds_read_b64_tr_b16 v[186:187], v35 offset:51712
v_fma_f32 v61, v45, v58, v60
v_fmac_f32_dpp v61, v58, v46 row_ror:8 row_mask:0xf bank_mask:0xf
v_mov_b32 v62, v61
v_add_u32 v63, 155648, v63
s_sub_u32 s51, 31, s11
v_mfma_f32_32x32x16_bf16 v[224:239], v[188:191], a[24:27], v[224:239]
buffer_load_dwordx4 v11, s[64:67], s100 offen offset:1024 lds
v_permlane32_swap_b32 v61, v62
s_lshl_b32 s51, s51, 7
v_lshlrev_b32 v9, 3, v2
v_fma_f32 v8, v47, v61, v62
s_waitcnt lgkmcnt(2)
v_mfma_f32_32x32x16_bf16 v[208:223], v[176:179], a[36:39], v[208:223]
ds_read_b64_tr_b16 v[188:189], v36 offset:51200
ds_read_b64_tr_b16 v[190:191], v36 offset:51712
v_fmac_f32_dpp v8, v61, v48 row_ror:8 row_mask:0xf bank_mask:0xf
v_bfe_u32 v9, s14, v9, 8
s_movk_i32 s81, 0xff00
v_lshl_add_u32 v57, v2, 2, s51
v_and_or_b32 v8, v8, s81, v9
v_mfma_f32_32x32x16_bf16 v[192:207], v[176:179], a[32:35], v[192:207]
buffer_load_dwordx4 v12, s[64:67], s100 offen offset:2048 lds
s_add_u32 s51, s51, 128
buffer_store_dword v8, v57, s[76:79], 0 offen sc1
s_nop 0
v_mfma_f32_32x32x16_bf16 v[240:255], v[180:183], a[36:39], v[240:255]
v_lshl_add_u32 v57, v1, 4, s51
ds_read_b128 v[128:131], v63
ds_read_b128 v[132:135], v63 offset:512
v_mul_f32_dpp v59, v144, v56 row_ror:8 row_mask:0xf bank_mask:0xf
v_fma_f32 v144, v144, v55, v59
v_mfma_f32_32x32x16_bf16 v[224:239], v[180:183], a[32:35], v[224:239]
s_waitcnt vmcnt(12)
ds_read_b64_tr_b16 v[176:177], v37 offset:0
buffer_load_dwordx4 v13, s[64:67], s100 offen offset:3072 lds
s_add_u32 m0, s15, 32768
s_add_u32 s100, s100, 114688
s_waitcnt lgkmcnt(3)
v_mfma_f32_32x32x16_bf16 v[208:223], v[184:187], a[44:47], v[208:223]
ds_read_b64_tr_b16 v[178:179], v37 offset:512
ds_read_b64_tr_b16 v[180:181], v38 offset:0
ds_read_b64_tr_b16 v[182:183], v38 offset:512
v_mul_f32_dpp v60, v145, v56 row_ror:8 row_mask:0xf bank_mask:0xf
v_fma_f32 v145, v145, v55, v60
v_mul_f32_dpp v59, v146, v56 row_ror:8 row_mask:0xf bank_mask:0xf
v_mfma_f32_32x32x16_bf16 v[192:207], v[184:187], a[40:43], v[192:207]
buffer_load_dwordx4 v10, s[64:67], s100 offen offset:0 lds
v_fma_f32 v146, v146, v55, v59
v_mul_f32_dpp v60, v147, v56 row_ror:8 row_mask:0xf bank_mask:0xf
v_fma_f32 v147, v147, v55, v60
v_mul_f32_dpp v59, v148, v56 row_ror:8 row_mask:0xf bank_mask:0xf
v_fma_f32 v148, v148, v55, v59
v_mul_f32_dpp v60, v149, v56 row_ror:8 row_mask:0xf bank_mask:0xf
v_mfma_f32_32x32x16_bf16 v[240:255], v[188:191], a[44:47], v[240:255]
ds_read_b64_tr_b16 v[184:185], v37 offset:2048
ds_read_b64_tr_b16 v[186:187], v37 offset:2560
v_fma_f32 v149, v149, v55, v60
v_mul_f32_dpp v59, v150, v56 row_ror:8 row_mask:0xf bank_mask:0xf
v_fma_f32 v150, v150, v55, v59
v_mul_f32_dpp v60, v151, v56 row_ror:8 row_mask:0xf bank_mask:0xf
v_fma_f32 v151, v151, v55, v60
v_mfma_f32_32x32x16_bf16 v[224:239], v[188:191], a[40:43], v[224:239]
buffer_load_dwordx4 v11, s[64:67], s100 offen offset:1024 lds
s_waitcnt lgkmcnt(7)
v_add_f32 v128, v128, v129
s_waitcnt lgkmcnt(6)
v_add_f32 v132, v132, v133
v_add_f32 v130, v130, v131
v_add_f32 v134, v134, v135
v_add_f32 v128, v128, v130
s_waitcnt lgkmcnt(2)
v_mfma_f32_32x32x16_bf16 v[208:223], v[176:179], a[52:55], v[208:223]
ds_read_b64_tr_b16 v[188:189], v38 offset:2048
ds_read_b64_tr_b16 v[190:191], v38 offset:2560
v_add_f32 v132, v132, v134
v_mul_f32 v128, 0xbfb8aa3b, v128
v_mul_f32 v132, 0xbfb8aa3b, v132
v_min_f32 v128, 0x42a00000, v128
v_min_f32 v132, 0x42a00000, v132
v_mfma_f32_32x32x16_bf16 v[192:207], v[176:179], a[48:51], v[192:207]
buffer_load_dwordx4 v12, s[64:67], s100 offen offset:2048 lds
v_exp_f32 v4, v128
v_exp_f32 v6, v132
v_lshlrev_b32 v130, 7, v3
v_add_f32 v128, 1.0, v4
v_mfma_f32_32x32x16_bf16 v[240:255], v[180:183], a[52:55], v[240:255]
v_add_f32 v132, 1.0, v6
v_rcp_f32 v128, v128
v_rcp_f32 v132, v132
v_add_u32 v130, 156672, v130
s_lshr_b32 s50, s3, 1
v_mfma_f32_32x32x16_bf16 v[224:239], v[180:183], a[48:51], v[224:239]
s_waitcnt vmcnt(12)
ds_read_b64_tr_b16 v[176:177], v37 offset:16384
buffer_load_dwordx4 v13, s[64:67], s100 offen offset:3072 lds
s_add_u32 m0, s15, 49152
s_mul_i32 s100, s8, 1792
s_waitcnt lgkmcnt(1)
v_mfma_f32_32x32x16_bf16 v[208:223], v[184:187], a[60:63], v[208:223]
ds_read_b64_tr_b16 v[178:179], v37 offset:16896
ds_read_b64_tr_b16 v[180:181], v38 offset:16384
ds_read_b64_tr_b16 v[182:183], v38 offset:16896
ds_write_b32 v137, v128
v_mfma_f32_32x32x16_bf16 v[192:207], v[184:187], a[56:59], v[192:207]
buffer_load_dwordx4 v10, s[64:67], s100 offen offset:0 lds
ds_write_b32 v137, v132 offset:64
v_lshl_add_u32 v131, s50, 6, v130
v_mfma_f32_32x32x16_bf16 v[240:255], v[188:191], a[60:63], v[240:255]
ds_read_b64_tr_b16 v[184:185], v37 offset:18432
ds_read_b64_tr_b16 v[186:187], v37 offset:18944
ds_read_b128 v[80:83], v131 offset:0
ds_read_b128 v[84:87], v131 offset:16
v_mfma_f32_32x32x16_bf16 v[224:239], v[188:191], a[56:59], v[224:239]
buffer_load_dwordx4 v11, s[64:67], s100 offen offset:1024 lds
ds_read_b128 v[88:91], v131 offset:32
ds_read_b128 v[92:95], v131 offset:48
v_mov_b32 v104, s14
s_waitcnt lgkmcnt(8)
v_mfma_f32_32x32x16_bf16 v[208:223], v[176:179], a[68:71], v[208:223]
ds_read_b64_tr_b16 v[188:189], v38 offset:18432
ds_read_b64_tr_b16 v[190:191], v38 offset:18944
v_lshl_or_b32 v105, v1, 15, v1
v_lshrrev_b32 v108, 3, v1
v_xor_b32 v106, 1, v105
v_xor_b32 v107, 0x10000, v105
v_mul_u32_u24 v108, 1664, v108
v_mfma_f32_32x32x16_bf16 v[192:207], v[176:179], a[64:67], v[192:207]
buffer_load_dwordx4 v12, s[64:67], s100 offen offset:2048 lds
v_add_u32 v108, v108, v0
v_add_u32 v109, 14336, v108
s_mov_b32 s82, 0x10001
v_and_b32 v26, 1, v1
v_lshlrev_b32 v26, 4, v26
v_mov_b32 v27, 0x3f80
v_mfma_f32_32x32x16_bf16 v[240:255], v[180:183], a[68:71], v[240:255]
v_lshlrev_b32 v26, v26, v27
v_lshrrev_b32 v27, 3, v2
v_bfe_u32 v28, v1, 1, 1
v_lshl_add_u32 v27, v27, 1, v28
v_bfe_u32 v28, v1, 2, 1
v_xor_b32 v28, v28, v3
v_lshl_add_u32 v27, v28, 3, v27
v_mul_u32_u24 v28, 57344, v3
v_mfma_f32_32x32x16_bf16 v[224:239], v[180:183], a[64:67], v[224:239]
s_waitcnt vmcnt(12)
ds_read_b64_tr_b16 v[176:177], v35 offset:0
buffer_load_dwordx4 v13, s[64:67], s100 offen offset:3072 lds
s_add_u32 m0, s15, 65536
s_add_u32 s100, s100, 114688
s_waitcnt lgkmcnt(1)
v_mfma_f32_32x32x16_bf16 v[208:223], v[184:187], a[76:79], v[208:223]
ds_read_b64_tr_b16 v[178:179], v35 offset:512
ds_read_b64_tr_b16 v[180:181], v36 offset:0
ds_read_b64_tr_b16 v[182:183], v36 offset:512
v_lshl_add_u32 v110, v2, 2, v28
v_lshl_add_u32 v110, s12, 8, v110
v_cmp_eq_u32 vcc, 0, v27
v_mfma_f32_32x32x16_bf16 v[192:207], v[184:187], a[72:75], v[192:207]
buffer_load_dwordx4 v10, s[64:67], s100 offen offset:0 lds
v_cmp_eq_u32 s[42:43], 1, v27
v_mul_f32_dpp v59, v152, v56 row_ror:8 row_mask:0xf bank_mask:0xf
v_fma_f32 v152, v152, v55, v59
v_cndmask_b32 v96, 0, v26
v_cmp_eq_u32 vcc, 2, v27
v_mul_f32_dpp v60, v153, v56 row_ror:8 row_mask:0xf bank_mask:0xf
v_mfma_f32_32x32x16_bf16 v[240:255], v[188:191], a[76:79], v[240:255]
ds_read_b64_tr_b16 v[184:185], v35 offset:2048
ds_read_b64_tr_b16 v[186:187], v35 offset:2560
v_fma_f32 v153, v153, v55, v60
v_cndmask_b32 v97, 0, v26, s[42:43]
v_cmp_eq_u32 s[42:43], 3, v27
v_mul_f32_dpp v59, v154, v56 row_ror:8 row_mask:0xf bank_mask:0xf
v_mfma_f32_32x32x16_bf16 v[224:239], v[188:191], a[72:75], v[224:239]
buffer_load_dwordx4 v11, s[64:67], s100 offen offset:1024 lds
v_fma_f32 v154, v154, v55, v59
v_cndmask_b32 v98, 0, v26
v_cmp_eq_u32 vcc, 4, v27
v_mul_f32_dpp v60, v155, v56 row_ror:8 row_mask:0xf bank_mask:0xf
s_waitcnt lgkmcnt(2)
v_mfma_f32_32x32x16_bf16 v[208:223], v[176:179], a[84:87], v[208:223]
ds_read_b64_tr_b16 v[188:189], v36 offset:2048
ds_read_b64_tr_b16 v[190:191], v36 offset:2560
v_fma_f32 v155, v155, v55, v60
v_cndmask_b32 v99, 0, v26, s[42:43]
v_cmp_eq_u32 s[42:43], 5, v27
v_mul_f32_dpp v59, v156, v56 row_ror:8 row_mask:0xf bank_mask:0xf
v_mfma_f32_32x32x16_bf16 v[192:207], v[176:179], a[80:83], v[192:207]
buffer_load_dwordx4 v12, s[64:67], s100 offen offset:2048 lds
v_fma_f32 v156, v156, v55, v59
v_cndmask_b32 v100, 0, v26
v_cmp_eq_u32 vcc, 6, v27
v_mul_f32_dpp v60, v157, v56 row_ror:8 row_mask:0xf bank_mask:0xf
v_fma_f32 v157, v157, v55, v60
v_mfma_f32_32x32x16_bf16 v[240:255], v[180:183], a[84:87], v[240:255]
v_cndmask_b32 v101, 0, v26, s[42:43]
v_cmp_eq_u32 s[42:43], 7, v27
v_mul_f32_dpp v59, v158, v56 row_ror:8 row_mask:0xf bank_mask:0xf
v_fma_f32 v158, v158, v55, v59
v_cndmask_b32 v102, 0, v26
v_mul_f32_dpp v60, v159, v56 row_ror:8 row_mask:0xf bank_mask:0xf
v_fma_f32 v159, v159, v55, v60
v_mfma_f32_32x32x16_bf16 v[224:239], v[180:183], a[80:83], v[224:239]
s_waitcnt vmcnt(11)
ds_read_b64_tr_b16 v[176:177], v35 offset:16384
ds_read_b64_tr_b16 v[178:179], v35 offset:16896
v_cndmask_b32 v103, 0, v26, s[42:43]
v_mul_f32_dpp v59, v160, v56 row_ror:8 row_mask:0xf bank_mask:0xf
s_waitcnt lgkmcnt(2)
v_mfma_f32_32x32x16_bf16 v[208:223], v[184:187], a[92:95], v[208:223]
buffer_load_dwordx4 v13, s[64:67], s100 offen offset:3072 lds
s_add_u32 m0, s15, 81920
s_mul_i32 s100, s9, 1792
ds_read_b64_tr_b16 v[180:181], v36 offset:16384
v_fma_f32 v160, v160, v55, v59
v_mfma_f32_32x32x16_bf16 v[192:207], v[184:187], a[88:91], v[192:207]
buffer_load_dwordx4 v10, s[64:67], s100 offen offset:0 lds
ds_read_b64_tr_b16 v[182:183], v36 offset:16896
v_mul_f32_dpp v60, v161, v56 row_ror:8 row_mask:0xf bank_mask:0xf
v_fma_f32 v161, v161, v55, v60
v_mul_f32_dpp v59, v162, v56 row_ror:8 row_mask:0xf bank_mask:0xf
v_mfma_f32_32x32x16_bf16 v[240:255], v[188:191], a[92:95], v[240:255]
ds_read_b64_tr_b16 v[184:185], v35 offset:18432
ds_read_b64_tr_b16 v[186:187], v35 offset:18944
v_fma_f32 v162, v162, v55, v59
v_mul_f32_dpp v60, v163, v56 row_ror:8 row_mask:0xf bank_mask:0xf
v_fma_f32 v163, v163, v55, v60
v_mul_f32_dpp v59, v164, v56 row_ror:8 row_mask:0xf bank_mask:0xf
v_mfma_f32_32x32x16_bf16 v[224:239], v[188:191], a[88:91], v[224:239]
buffer_load_dwordx4 v11, s[64:67], s100 offen offset:1024 lds
v_fma_f32 v164, v164, v55, v59
v_mul_f32_dpp v60, v165, v56 row_ror:8 row_mask:0xf bank_mask:0xf
v_fma_f32 v165, v165, v55, v60
v_mul_f32_dpp v59, v166, v56 row_ror:8 row_mask:0xf bank_mask:0xf
s_waitcnt lgkmcnt(2)
v_mfma_f32_32x32x16_bf16 v[208:223], v[176:179], a[100:103], v[208:223]
ds_read_b64_tr_b16 v[188:189], v36 offset:18432
ds_read_b64_tr_b16 v[190:191], v36 offset:18944
v_fma_f32 v166, v166, v55, v59
v_mul_f32_dpp v60, v167, v56 row_ror:8 row_mask:0xf bank_mask:0xf
v_fma_f32 v167, v167, v55, v60
v_min_u32 v42, 6, v1
v_mfma_f32_32x32x16_bf16 v[192:207], v[176:179], a[96:99], v[192:207]
buffer_load_dwordx4 v12, s[64:67], s100 offen offset:2048 lds
v_lshlrev_b32 v42, 2, v42
buffer_load_dword v42, v42, s[84:87], 0 offen offset:0 sc1
v_mfma_f32_32x32x16_bf16 v[240:255], v[180:183], a[100:103], v[240:255]
v_mul_f32_dpp v59, v168, v56 row_ror:8 row_mask:0xf bank_mask:0xf
v_fma_f32 v168, v168, v55, v59
v_mul_f32_dpp v60, v169, v56 row_ror:8 row_mask:0xf bank_mask:0xf
v_fma_f32 v169, v169, v55, v60
v_mul_f32_dpp v59, v170, v56 row_ror:8 row_mask:0xf bank_mask:0xf
v_fma_f32 v170, v170, v55, v59
v_mul_f32_dpp v60, v171, v56 row_ror:8 row_mask:0xf bank_mask:0xf
v_mfma_f32_32x32x16_bf16 v[224:239], v[180:183], a[96:99], v[224:239]
s_waitcnt vmcnt(12)
ds_read_b64_tr_b16 v[176:177], v35 offset:32768
buffer_load_dwordx4 v13, s[64:67], s100 offen offset:3072 lds
s_add_u32 m0, s15, 114688
s_waitcnt lgkmcnt(1)
v_mfma_f32_32x32x16_bf16 v[208:223], v[184:187], a[108:111], v[208:223]
ds_read_b64_tr_b16 v[178:179], v35 offset:33280
ds_read_b64_tr_b16 v[180:181], v36 offset:32768
ds_read_b64_tr_b16 v[182:183], v36 offset:33280
v_fma_f32 v171, v171, v55, v60
v_mul_f32_dpp v59, v172, v56 row_ror:8 row_mask:0xf bank_mask:0xf
v_mfma_f32_32x32x16_bf16 v[192:207], v[184:187], a[104:107], v[192:207]
buffer_load_dwordx4 v57, s[76:79], 0 offen offset:0 sc1 lds
v_fma_f32 v172, v172, v55, v59
v_mul_f32_dpp v60, v173, v56 row_ror:8 row_mask:0xf bank_mask:0xf
v_fma_f32 v173, v173, v55, v60
v_mul_f32_dpp v59, v174, v56 row_ror:8 row_mask:0xf bank_mask:0xf
v_fma_f32 v174, v174, v55, v59
v_mfma_f32_32x32x16_bf16 v[240:255], v[188:191], a[108:111], v[240:255]
buffer_load_dwordx4 v57, s[76:79], 0 offen offset:1024 sc1 lds
ds_read_b64_tr_b16 v[184:185], v35 offset:34816
ds_read_b64_tr_b16 v[186:187], v35 offset:35328
v_mul_f32_dpp v60, v175, v56 row_ror:8 row_mask:0xf bank_mask:0xf
v_mfma_f32_32x32x16_bf16 v[224:239], v[188:191], a[104:107], v[224:239]
buffer_load_dwordx4 v57, s[76:79], 0 offen offset:2048 sc1 lds
v_fma_f32 v175, v175, v55, v60
v_lshlrev_b32 v59, 4, v3
v_cmp_eq_u32 vcc, 1, v3
v_sub_u32 v59, s11, v59
s_waitcnt lgkmcnt(2)
v_mfma_f32_32x32x16_bf16 v[208:223], v[176:179], a[116:119], v[208:223]
buffer_load_dwordx4 v57, s[76:79], 0 offen offset:3072 sc1 lds
s_add_u32 m0, s15, 0
s_add_u32 s100, s100, 114688
ds_read_b64_tr_b16 v[188:189], v36 offset:34816
v_add_u32 v129, 128, v141
v_mfma_f32_32x32x16_bf16 v[192:207], v[176:179], a[112:115], v[192:207]
buffer_load_dwordx4 v10, s[64:67], s100 offen offset:0 lds
ds_read_b64_tr_b16 v[190:191], v36 offset:35328
v_cndmask_b32 v47, 1.0, v47
v_med3_i32 v59, v59, 0, 16
v_cndmask_b32 v48, 0, v48
v_mfma_f32_32x32x16_bf16 v[240:255], v[180:183], a[116:119], v[240:255]
v_mul_u32_u24 v9, v59, v9
v_cndmask_b32 v61, 0, v61
v_mfma_f32_32x32x16_bf16 v[224:239], v[180:183], a[112:115], v[224:239]
s_waitcnt vmcnt(14)
ds_read_b64_tr_b16 v[176:177], v35 offset:49152
buffer_load_dwordx4 v11, s[64:67], s100 offen offset:1024 lds
s_waitcnt lgkmcnt(1)
v_mfma_f32_32x32x16_bf16 v[208:223], v[184:187], a[124:127], v[208:223]
ds_read_b64_tr_b16 v[178:179], v35 offset:49664
ds_read_b64_tr_b16 v[180:181], v36 offset:49152
ds_read_b64_tr_b16 v[182:183], v36 offset:49664
v_mfma_f32_32x32x16_bf16 v[192:207], v[184:187], a[120:123], v[192:207]
buffer_load_dwordx4 v12, s[64:67], s100 offen offset:2048 lds
v_mfma_f32_32x32x16_bf16 v[240:255], v[188:191], a[124:127], v[240:255]
ds_read_b64_tr_b16 v[184:185], v35 offset:51200
ds_read_b64_tr_b16 v[186:187], v35 offset:51712
v_mfma_f32_32x32x16_bf16 v[224:239], v[188:191], a[120:123], v[224:239]
buffer_load_dwordx4 v13, s[64:67], s100 offen offset:3072 lds
s_add_u32 m0, s15, 16384
s_mul_i32 s100, s10, 1792
s_waitcnt lgkmcnt(2)
v_mfma_f32_32x32x16_bf16 v[208:223], v[176:179], a[132:135], v[208:223]
ds_read_b64_tr_b16 v[188:189], v36 offset:51200
ds_read_b64_tr_b16 v[190:191], v36 offset:51712
v_mfma_f32_32x32x16_bf16 v[192:207], v[176:179], a[128:131], v[192:207]
buffer_load_dwordx4 v10, s[64:67], s100 offen offset:0 lds
v_mfma_f32_32x32x16_bf16 v[240:255], v[180:183], a[132:135], v[240:255]
v_mfma_f32_32x32x16_bf16 v[224:239], v[180:183], a[128:131], v[224:239]
s_waitcnt vmcnt(14)
ds_read_b64_tr_b16 v[176:177], v37 offset:0
buffer_load_dwordx4 v11, s[64:67], s100 offen offset:1024 lds
s_waitcnt lgkmcnt(1)
v_mfma_f32_32x32x16_bf16 v[208:223], v[184:187], a[140:143], v[208:223]
ds_read_b64_tr_b16 v[178:179], v37 offset:512
ds_read_b64_tr_b16 v[180:181], v38 offset:0
ds_read_b64_tr_b16 v[182:183], v38 offset:512
v_mfma_f32_32x32x16_bf16 v[192:207], v[184:187], a[136:139], v[192:207]
buffer_load_dwordx4 v12, s[64:67], s100 offen offset:2048 lds
v_mfma_f32_32x32x16_bf16 v[240:255], v[188:191], a[140:143], v[240:255]
ds_read_b64_tr_b16 v[184:185], v37 offset:2048
ds_read_b64_tr_b16 v[186:187], v37 offset:2560
v_mfma_f32_32x32x16_bf16 v[224:239], v[188:191], a[136:139], v[224:239]
buffer_load_dwordx4 v13, s[64:67], s100 offen offset:3072 lds
s_add_u32 m0, s15, 32768
s_add_u32 s100, s100, 114688
s_waitcnt lgkmcnt(2)
v_mfma_f32_32x32x16_bf16 v[208:223], v[176:179], a[148:151], v[208:223]
ds_read_b64_tr_b16 v[188:189], v38 offset:2048
ds_read_b64_tr_b16 v[190:191], v38 offset:2560
s_waitcnt vmcnt(8)
ds_read2st64_b32 v[126:127], v129 offset0:3 offset1:7
v_mfma_f32_32x32x16_bf16 v[192:207], v[176:179], a[144:147], v[192:207]
buffer_load_dwordx4 v10, s[64:67], s100 offen offset:0 lds
ds_read2st64_b32 v[124:125], v141 offset0:3 offset1:7
ds_read2st64_b32 v[122:123], v129 offset0:2 offset1:6
v_mfma_f32_32x32x16_bf16 v[240:255], v[180:183], a[148:151], v[240:255]
ds_read2st64_b32 v[120:121], v141 offset0:2 offset1:6
ds_read2st64_b32 v[118:119], v129 offset0:1 offset1:5
ds_read2st64_b32 v[116:117], v141 offset0:1 offset1:5
ds_read2st64_b32 v[114:115], v129 offset0:0 offset1:4
v_mfma_f32_32x32x16_bf16 v[224:239], v[180:183], a[144:147], v[224:239]
ds_read_b64_tr_b16 v[176:177], v37 offset:16384
buffer_load_dwordx4 v11, s[64:67], s100 offen offset:1024 lds
s_waitcnt lgkmcnt(8)
v_mfma_f32_32x32x16_bf16 v[208:223], v[184:187], a[156:159], v[208:223]
ds_read_b64_tr_b16 v[178:179], v37 offset:16896
ds_read_b64_tr_b16 v[180:181], v38 offset:16384
ds_read_b64_tr_b16 v[182:183], v38 offset:16896
ds_read2st64_b32 v[112:113], v141 offset0:0 offset1:4
v_mfma_f32_32x32x16_bf16 v[192:207], v[184:187], a[152:155], v[192:207]
buffer_load_dwordx4 v12, s[64:67], s100 offen offset:2048 lds
v_xor_b32 v23, 16, v140
v_xor_b32 v24, 32, v140
v_xor_b32 v25, 48, v140
v_xor_b32 v26, 64, v140
v_xor_b32 v27, 80, v140
v_mfma_f32_32x32x16_bf16 v[240:255], v[188:191], a[156:159], v[240:255]
ds_read_b64_tr_b16 v[184:185], v37 offset:18432
ds_read_b64_tr_b16 v[186:187], v37 offset:18944
v_xor_b32 v28, 96, v140
v_xor_b32 v29, 112, v140
v_add_u32 v41, 0x10000, v29
v_add_u32 v40, 0x10000, v28
v_mfma_f32_32x32x16_bf16 v[224:239], v[188:191], a[152:155], v[224:239]
buffer_load_dwordx4 v13, s[64:67], s100 offen offset:3072 lds
s_add_u32 m0, s15, 49152
s_mul_i32 s100, s92, 448
v_add_u32 v39, 0x10000, v27
v_add_u32 v34, 0x10000, v26
s_waitcnt lgkmcnt(3)
v_mfma_f32_32x32x16_bf16 v[208:223], v[176:179], a[164:167], v[208:223]
ds_read_b64_tr_b16 v[188:189], v38 offset:18432
ds_read_b64_tr_b16 v[190:191], v38 offset:18944
v_add_u32_sdwa v130, v126, v127 dst_sel:DWORD dst_unused:UNUSED_PAD src0_sel:BYTE_0 src1_sel:BYTE_0
v_add_u32_sdwa v131, v124, v125 dst_sel:DWORD dst_unused:UNUSED_PAD src0_sel:BYTE_0 src1_sel:BYTE_0
v_add3_u32 v8, v130, v131, 0
v_add_u32_sdwa v130, v122, v123 dst_sel:DWORD dst_unused:UNUSED_PAD src0_sel:BYTE_0 src1_sel:BYTE_0
v_mfma_f32_32x32x16_bf16 v[192:207], v[176:179], a[160:163], v[192:207]
buffer_load_dwordx4 v14, s[68:71], s100 offen offset:0 lds
v_add_u32_sdwa v131, v120, v121 dst_sel:DWORD dst_unused:UNUSED_PAD src0_sel:BYTE_0 src1_sel:BYTE_0
v_add3_u32 v8, v130, v131, v8
v_add_u32_sdwa v130, v118, v119 dst_sel:DWORD dst_unused:UNUSED_PAD src0_sel:BYTE_0 src1_sel:BYTE_0
v_add_u32_sdwa v131, v116, v117 dst_sel:DWORD dst_unused:UNUSED_PAD src0_sel:BYTE_0 src1_sel:BYTE_0
v_add3_u32 v8, v130, v131, v8
v_mfma_f32_32x32x16_bf16 v[240:255], v[180:183], a[164:167], v[240:255]
v_add_u32_sdwa v130, v114, v115 dst_sel:DWORD dst_unused:UNUSED_PAD src0_sel:BYTE_0 src1_sel:BYTE_0
s_waitcnt lgkmcnt(4)
v_add_u32_sdwa v131, v112, v113 dst_sel:DWORD dst_unused:UNUSED_PAD src0_sel:BYTE_0 src1_sel:BYTE_0
v_add3_u32 v8, v130, v131, v8
v_cmp_ne_u32 vcc, v8, v9
s_cbranch_vccnz L_eretry
L_eback:
v_and_b32 v126, s81, v126
v_mfma_f32_32x32x16_bf16 v[224:239], v[180:183], a[160:163], v[224:239]
s_waitcnt vmcnt(9)
ds_read_b64_tr_b16 v[176:177], v35 offset:0
buffer_load_dwordx4 v15, s[68:71], s100 offen offset:1024 lds
v_and_b32 v127, s81, v127
s_waitcnt lgkmcnt(1)
v_mfma_f32_32x32x16_bf16 v[208:223], v[184:187], a[172:175], v[208:223]
ds_read_b64_tr_b16 v[178:179], v35 offset:512
ds_read_b64_tr_b16 v[180:181], v36 offset:0
ds_read_b64_tr_b16 v[182:183], v36 offset:512
v_and_b32 v124, s81, v124
v_and_b32 v125, s81, v125
v_mfma_f32_32x32x16_bf16 v[192:207], v[184:187], a[168:171], v[192:207]
buffer_load_dwordx4 v16, s[68:71], s100 offen offset:2048 lds
v_fmac_f32 v124, v49, v126
v_fmac_f32 v125, v49, v127
v_fmac_f32_dpp v124, v126, v50 row_ror:8 row_mask:0xf bank_mask:0xf
v_fmac_f32_dpp v125, v127, v50 row_ror:8 row_mask:0xf bank_mask:0xf
v_and_b32 v122, s81, v122
v_mfma_f32_32x32x16_bf16 v[240:255], v[188:191], a[172:175], v[240:255]
ds_read_b64_tr_b16 v[184:185], v35 offset:2048
ds_read_b64_tr_b16 v[186:187], v35 offset:2560
v_and_b32 v123, s81, v123
v_fmac_f32 v122, v49, v124
v_fmac_f32 v123, v49, v125
v_fmac_f32_dpp v122, v124, v50 row_ror:8 row_mask:0xf bank_mask:0xf
v_mfma_f32_32x32x16_bf16 v[224:239], v[188:191], a[168:171], v[224:239]
buffer_load_dwordx4 v17, s[68:71], s100 offen offset:3072 lds
s_add_u32 m0, s15, 65536
s_mov_b32 s100, s92
v_fmac_f32_dpp v123, v125, v50 row_ror:8 row_mask:0xf bank_mask:0xf
v_and_b32 v120, s81, v120
s_waitcnt lgkmcnt(2)
v_mfma_f32_32x32x16_bf16 v[208:223], v[176:179], a[180:183], v[208:223]
ds_read_b64_tr_b16 v[188:189], v36 offset:2048
ds_read_b64_tr_b16 v[190:191], v36 offset:2560
v_and_b32 v121, s81, v121
v_fmac_f32 v120, v49, v122
v_fmac_f32 v121, v49, v123
v_fmac_f32_dpp v120, v122, v50 row_ror:8 row_mask:0xf bank_mask:0xf
v_mfma_f32_32x32x16_bf16 v[192:207], v[176:179], a[176:179], v[192:207]
buffer_load_dwordx4 v18, s[72:75], s100 offen offset:0 lds
v_fmac_f32_dpp v121, v123, v50 row_ror:8 row_mask:0xf bank_mask:0xf
v_and_b32 v118, s81, v118
v_and_b32 v119, s81, v119
v_fmac_f32 v118, v49, v120
v_fmac_f32 v119, v49, v121
v_mfma_f32_32x32x16_bf16 v[240:255], v[180:183], a[180:183], v[240:255]
v_fmac_f32_dpp v118, v120, v50 row_ror:8 row_mask:0xf bank_mask:0xf
v_fmac_f32_dpp v119, v121, v50 row_ror:8 row_mask:0xf bank_mask:0xf
v_and_b32 v116, s81, v116
v_and_b32 v117, s81, v117
v_fmac_f32 v116, v49, v118
v_fmac_f32 v117, v49, v119
v_fmac_f32_dpp v116, v118, v50 row_ror:8 row_mask:0xf bank_mask:0xf
v_mfma_f32_32x32x16_bf16 v[224:239], v[180:183], a[176:179], v[224:239]
s_waitcnt vmcnt(9)
ds_read_b64_tr_b16 v[176:177], v35 offset:16384
buffer_load_dwordx4 v19, s[72:75], s100 offen offset:1024 lds
v_fmac_f32_dpp v117, v119, v50 row_ror:8 row_mask:0xf bank_mask:0xf
s_waitcnt lgkmcnt(1)
v_mfma_f32_32x32x16_bf16 v[208:223], v[184:187], a[188:191], v[208:223]
ds_read_b64_tr_b16 v[178:179], v35 offset:16896
ds_read_b64_tr_b16 v[180:181], v36 offset:16384
ds_read_b64_tr_b16 v[182:183], v36 offset:16896
v_and_b32 v114, s81, v114
v_and_b32 v115, s81, v115
v_mfma_f32_32x32x16_bf16 v[192:207], v[184:187], a[184:187], v[192:207]
buffer_load_dwordx4 v20, s[72:75], s100 offen offset:2048 lds
v_fmac_f32 v114, v49, v116
v_fmac_f32 v115, v49, v117
v_fmac_f32_dpp v114, v116, v50 row_ror:8 row_mask:0xf bank_mask:0xf
v_fmac_f32_dpp v115, v117, v50 row_ror:8 row_mask:0xf bank_mask:0xf
v_and_b32 v112, s81, v112
v_mfma_f32_32x32x16_bf16 v[240:255], v[188:191], a[188:191], v[240:255]
ds_read_b64_tr_b16 v[184:185], v35 offset:18432
ds_read_b64_tr_b16 v[186:187], v35 offset:18944
v_and_b32 v113, s81, v113
v_fmac_f32 v112, v49, v114
v_fmac_f32 v113, v49, v115
v_fmac_f32_dpp v112, v114, v50 row_ror:8 row_mask:0xf bank_mask:0xf
v_mfma_f32_32x32x16_bf16 v[224:239], v[188:191], a[184:187], v[224:239]
buffer_load_dwordx4 v21, s[72:75], s100 offen offset:3072 lds
s_add_u32 m0, s15, 81920
s_add_u32 s100, s92, 114688
v_fmac_f32_dpp v113, v115, v50 row_ror:8 row_mask:0xf bank_mask:0xf
v_fmac_f32 v112, v51, v113
s_waitcnt lgkmcnt(2)
v_mfma_f32_32x32x16_bf16 v[208:223], v[176:179], a[196:199], v[208:223]
ds_read_b64_tr_b16 v[188:189], v36 offset:18432
ds_read_b64_tr_b16 v[190:191], v36 offset:18944
v_xor_b32 v121, 16, v138
v_fmac_f32_dpp v112, v113, v52 row_ror:8 row_mask:0xf bank_mask:0xf
v_mov_b32 v113, v112
v_xor_b32 v122, 32, v138
v_mfma_f32_32x32x16_bf16 v[192:207], v[176:179], a[192:195], v[192:207]
buffer_load_dwordx4 v18, s[72:75], s100 offen offset:0 lds
v_xor_b32 v123, 48, v138
v_permlane32_swap_b32 v112, v113
v_add_u32 v33, 0x10000, v25
v_fmac_f32 v112, v53, v113
v_mfma_f32_32x32x16_bf16 v[240:255], v[180:183], a[196:199], v[240:255]
v_fmac_f32_dpp v112, v113, v54 row_ror:8 row_mask:0xf bank_mask:0xf
v_add_u32 v32, 0x10000, v24
v_fma_f32 v114, v47, v112, v61
v_fmac_f32_dpp v114, v112, v48 row_ror:8 row_mask:0xf bank_mask:0xf
v_add_u32 v31, 0x10000, v23
v_fma_f32 v115, v45, v114, v58
v_fmac_f32_dpp v115, v114, v46 row_ror:8 row_mask:0xf bank_mask:0xf
v_mfma_f32_32x32x16_bf16 v[224:239], v[180:183], a[192:195], v[224:239]
s_waitcnt vmcnt(9)
ds_read_b64_tr_b16 v[176:177], v35 offset:32768
buffer_load_dwordx4 v19, s[72:75], s100 offen offset:1024 lds
v_mul_f32_dpp v112, v114, v56 row_ror:8 row_mask:0xf bank_mask:0xf
s_waitcnt lgkmcnt(1)
v_mfma_f32_32x32x16_bf16 v[208:223], v[184:187], a[204:207], v[208:223]
ds_read_b64_tr_b16 v[178:179], v35 offset:33280
ds_read_b64_tr_b16 v[180:181], v36 offset:32768
ds_read_b64_tr_b16 v[182:183], v36 offset:33280
v_add_u32 v30, 0x10000, v140
v_mul_f32_dpp v113, v115, v56 row_ror:8 row_mask:0xf bank_mask:0xf
v_mfma_f32_32x32x16_bf16 v[192:207], v[184:187], a[200:203], v[192:207]
buffer_load_dwordx4 v20, s[72:75], s100 offen offset:2048 lds
v_fmac_f32 v112, v114, v55
v_fmac_f32 v113, v115, v55
v_fmac_f32 v144, v43, v112
v_fmac_f32 v160, v43, v113
v_fmac_f32_dpp v144, v112, -v44 row_ror:8 row_mask:0xf bank_mask:0xf
v_mfma_f32_32x32x16_bf16 v[240:255], v[188:191], a[204:207], v[240:255]
ds_read_b64_tr_b16 v[184:185], v35 offset:34816
ds_read_b64_tr_b16 v[186:187], v35 offset:35328
v_fmac_f32_dpp v160, v113, -v44 row_ror:8 row_mask:0xf bank_mask:0xf
v_fmac_f32 v145, v43, v144
v_fmac_f32 v161, v43, v160
v_fmac_f32_dpp v145, v144, -v44 row_ror:8 row_mask:0xf bank_mask:0xf
v_mfma_f32_32x32x16_bf16 v[224:239], v[188:191], a[200:203], v[224:239]
buffer_load_dwordx4 v21, s[72:75], s100 offen offset:3072 lds
v_fmac_f32_dpp v161, v160, -v44 row_ror:8 row_mask:0xf bank_mask:0xf
v_fmac_f32 v146, v43, v145
v_fmac_f32 v162, v43, v161
v_fmac_f32_dpp v146, v145, -v44 row_ror:8 row_mask:0xf bank_mask:0xf
s_waitcnt lgkmcnt(2)
v_mfma_f32_32x32x16_bf16 v[208:223], v[176:179], a[212:215], v[208:223]
ds_read_b64_tr_b16 v[188:189], v36 offset:34816
ds_read_b64_tr_b16 v[190:191], v36 offset:35328
v_fmac_f32_dpp v162, v161, -v44 row_ror:8 row_mask:0xf bank_mask:0xf
v_fmac_f32 v147, v43, v146
v_fmac_f32 v163, v43, v162
v_fmac_f32_dpp v147, v146, -v44 row_ror:8 row_mask:0xf bank_mask:0xf
v_mfma_f32_32x32x16_bf16 v[192:207], v[176:179], a[208:211], v[192:207]
v_fmac_f32_dpp v163, v162, -v44 row_ror:8 row_mask:0xf bank_mask:0xf
v_fmac_f32 v148, v43, v147
v_fmac_f32 v164, v43, v163
v_fmac_f32_dpp v148, v147, -v44 row_ror:8 row_mask:0xf bank_mask:0xf
v_fmac_f32_dpp v164, v163, -v44 row_ror:8 row_mask:0xf bank_mask:0xf
v_fmac_f32 v149, v43, v148
v_fmac_f32 v165, v43, v164
v_mfma_f32_32x32x16_bf16 v[240:255], v[180:183], a[212:215], v[240:255]
v_fmac_f32_dpp v149, v148, -v44 row_ror:8 row_mask:0xf bank_mask:0xf
v_fmac_f32_dpp v165, v164, -v44 row_ror:8 row_mask:0xf bank_mask:0xf
v_fmac_f32 v150, v43, v149
v_fmac_f32 v166, v43, v165
v_fmac_f32_dpp v150, v149, -v44 row_ror:8 row_mask:0xf bank_mask:0xf
v_fmac_f32_dpp v166, v165, -v44 row_ror:8 row_mask:0xf bank_mask:0xf
v_fmac_f32 v151, v43, v150
v_mfma_f32_32x32x16_bf16 v[224:239], v[180:183], a[208:211], v[224:239]
v_fmac_f32 v167, v43, v166
v_fmac_f32_dpp v151, v150, -v44 row_ror:8 row_mask:0xf bank_mask:0xf
v_fmac_f32_dpp v167, v166, -v44 row_ror:8 row_mask:0xf bank_mask:0xf
v_fmac_f32 v152, v43, v151
v_fmac_f32 v168, v43, v167
v_fmac_f32_dpp v152, v151, -v44 row_ror:8 row_mask:0xf bank_mask:0xf
s_waitcnt lgkmcnt(0)
v_mfma_f32_32x32x16_bf16 v[208:223], v[184:187], a[220:223], v[208:223]
v_fmac_f32_dpp v168, v167, -v44 row_ror:8 row_mask:0xf bank_mask:0xf
v_cvt_pk_bf16_f32 v128, v144, v145
v_cvt_pk_bf16_f32 v129, v146, v147
v_cvt_pk_bf16_f32 v130, v148, v149
v_cvt_pk_bf16_f32 v131, v150, v151
v_mfma_f32_32x32x16_bf16 v[192:207], v[184:187], a[216:219], v[192:207]
ds_write_b128 v138, v[128:131]
v_fmac_f32 v153, v43, v152
v_fmac_f32 v169, v43, v168
v_mfma_f32_32x32x16_bf16 v[240:255], v[188:191], a[220:223], v[240:255]
v_fmac_f32_dpp v153, v152, -v44 row_ror:8 row_mask:0xf bank_mask:0xf
v_fmac_f32_dpp v169, v168, -v44 row_ror:8 row_mask:0xf bank_mask:0xf
v_fmac_f32 v154, v43, v153
v_fmac_f32 v170, v43, v169
v_fmac_f32_dpp v154, v153, -v44 row_ror:8 row_mask:0xf bank_mask:0xf
v_fmac_f32_dpp v170, v169, -v44 row_ror:8 row_mask:0xf bank_mask:0xf
v_fmac_f32 v155, v43, v154
v_mfma_f32_32x32x16_bf16 v[224:239], v[188:191], a[216:219], v[224:239]
v_fmac_f32 v171, v43, v170
v_fmac_f32_dpp v155, v154, -v44 row_ror:8 row_mask:0xf bank_mask:0xf
v_fmac_f32_dpp v171, v170, -v44 row_ror:8 row_mask:0xf bank_mask:0xf
v_fmac_f32 v156, v43, v155
v_fmac_f32 v172, v43, v171
v_fmac_f32_dpp v156, v155, -v44 row_ror:8 row_mask:0xf bank_mask:0xf
v_fmac_f32_dpp v172, v171, -v44 row_ror:8 row_mask:0xf bank_mask:0xf
v_cvt_pk_bf16_f32 v132, v160, v161
v_cvt_pk_bf16_f32 v133, v162, v163
v_cvt_pk_bf16_f32 v134, v164, v165
v_cvt_pk_bf16_f32 v135, v166, v167
ds_write_b128 v122, v[132:135]
v_fmac_f32 v157, v43, v156
v_fmac_f32 v173, v43, v172
v_fmac_f32_dpp v157, v156, -v44 row_ror:8 row_mask:0xf bank_mask:0xf
v_fmac_f32_dpp v173, v172, -v44 row_ror:8 row_mask:0xf bank_mask:0xf
v_fmac_f32 v158, v43, v157
v_fmac_f32 v174, v43, v173
v_fmac_f32_dpp v158, v157, -v44 row_ror:8 row_mask:0xf bank_mask:0xf
v_fmac_f32_dpp v174, v173, -v44 row_ror:8 row_mask:0xf bank_mask:0xf
v_fmac_f32 v159, v43, v158
v_fmac_f32 v175, v43, v174
v_fmac_f32_dpp v159, v158, -v44 row_ror:8 row_mask:0xf bank_mask:0xf
v_fmac_f32_dpp v175, v174, -v44 row_ror:8 row_mask:0xf bank_mask:0xf
v_add_u32 v45, 0x10000, v139
v_add_u32 v46, 0x20000, v139
v_pk_fma_f32 v[176:177], v[208:209], s[34:35], -0.5 op_sel_hi:[1,0,0]
v_pk_fma_f32 v[178:179], v[210:211], s[34:35], -0.5 op_sel_hi:[1,0,0]
v_pk_fma_f32 v[180:181], v[212:213], s[34:35], -0.5 op_sel_hi:[1,0,0]
v_pk_fma_f32 v[182:183], v[214:215], s[34:35], -0.5 op_sel_hi:[1,0,0]
v_exp_f32 v176, v176
v_exp_f32 v177, v177
v_exp_f32 v178, v178
v_exp_f32 v179, v179
v_exp_f32 v180, v180
v_exp_f32 v181, v181
v_exp_f32 v182, v182
v_exp_f32 v183, v183
v_pk_add_f32 v[176:177], v[176:177], s[36:37] op_sel_hi:[1,0]
v_pk_add_f32 v[178:179], v[178:179], s[36:37] op_sel_hi:[1,0]
v_pk_add_f32 v[180:181], v[180:181], s[36:37] op_sel_hi:[1,0]
v_pk_add_f32 v[182:183], v[182:183], s[36:37] op_sel_hi:[1,0]
v_pk_fma_f32 v[176:177], v[176:177], v[176:177], 0.5 op_sel_hi:[1,1,0]
v_pk_fma_f32 v[178:179], v[178:179], v[178:179], 0.5 op_sel_hi:[1,1,0]
v_pk_fma_f32 v[180:181], v[180:181], v[180:181], 0.5 op_sel_hi:[1,1,0]
v_pk_fma_f32 v[182:183], v[182:183], v[182:183], 0.5 op_sel_hi:[1,1,0]
v_cvt_pk_bf16_f32 v128, v152, v153
v_cvt_pk_bf16_f32 v129, v154, v155
v_cvt_pk_bf16_f32 v130, v156, v157
v_cvt_pk_bf16_f32 v131, v158, v159
ds_write_b128 v121, v[128:131]
v_rcp_f32 v176, v176
v_rcp_f32 v177, v177
v_rcp_f32 v178, v178
v_rcp_f32 v179, v179
v_rcp_f32 v180, v180
v_rcp_f32 v181, v181
v_rcp_f32 v182, v182
v_rcp_f32 v183, v183
v_pk_mul_f32 v[184:185], v[208:209], v[6:7] op_sel_hi:[1,0]
v_pk_mul_f32 v[186:187], v[210:211], v[6:7] op_sel_hi:[1,0]
v_pk_mul_f32 v[188:189], v[212:213], v[6:7] op_sel_hi:[1,0]
v_pk_mul_f32 v[190:191], v[214:215], v[6:7] op_sel_hi:[1,0]
v_pk_fma_f32 v[184:185], v[184:185], v[176:177], v[184:185] neg_lo:[1,0,0] neg_hi:[1,0,0]
v_pk_fma_f32 v[186:187], v[186:187], v[178:179], v[186:187] neg_lo:[1,0,0] neg_hi:[1,0,0]
v_pk_fma_f32 v[188:189], v[188:189], v[180:181], v[188:189] neg_lo:[1,0,0] neg_hi:[1,0,0]
v_pk_fma_f32 v[190:191], v[190:191], v[182:183], v[190:191] neg_lo:[1,0,0] neg_hi:[1,0,0]
v_cvt_pk_bf16_f32 v112, v184, v185
v_cvt_pk_bf16_f32 v113, v186, v187
v_cvt_pk_bf16_f32 v114, v188, v189
v_cvt_pk_bf16_f32 v115, v190, v191
ds_write_b128 v142, v[112:115] offset:16384
s_add_u32 m0, s15, 0
s_mul_i32 s100, s93, 448
buffer_load_dwordx4 v14, s[68:71], s100 offen offset:0 lds
v_pk_fma_f32 v[176:177], v[216:217], s[34:35], -0.5 op_sel_hi:[1,0,0]
v_pk_fma_f32 v[178:179], v[218:219], s[34:35], -0.5 op_sel_hi:[1,0,0]
v_pk_fma_f32 v[180:181], v[220:221], s[34:35], -0.5 op_sel_hi:[1,0,0]
v_pk_fma_f32 v[182:183], v[222:223], s[34:35], -0.5 op_sel_hi:[1,0,0]
v_exp_f32 v176, v176
v_exp_f32 v177, v177
v_exp_f32 v178, v178
v_exp_f32 v179, v179
v_exp_f32 v180, v180
v_exp_f32 v181, v181
v_exp_f32 v182, v182
v_exp_f32 v183, v183
v_pk_add_f32 v[176:177], v[176:177], s[36:37] op_sel_hi:[1,0]
v_pk_add_f32 v[178:179], v[178:179], s[36:37] op_sel_hi:[1,0]
v_pk_add_f32 v[180:181], v[180:181], s[36:37] op_sel_hi:[1,0]
v_pk_add_f32 v[182:183], v[182:183], s[36:37] op_sel_hi:[1,0]
v_pk_fma_f32 v[176:177], v[176:177], v[176:177], 0.5 op_sel_hi:[1,1,0]
v_pk_fma_f32 v[178:179], v[178:179], v[178:179], 0.5 op_sel_hi:[1,1,0]
v_pk_fma_f32 v[180:181], v[180:181], v[180:181], 0.5 op_sel_hi:[1,1,0]
v_pk_fma_f32 v[182:183], v[182:183], v[182:183], 0.5 op_sel_hi:[1,1,0]
v_cvt_pk_bf16_f32 v132, v168, v169
v_cvt_pk_bf16_f32 v133, v170, v171
v_cvt_pk_bf16_f32 v134, v172, v173
v_cvt_pk_bf16_f32 v135, v174, v175
ds_write_b128 v123, v[132:135]
v_rcp_f32 v176, v176
v_rcp_f32 v177, v177
v_rcp_f32 v178, v178
v_rcp_f32 v179, v179
v_rcp_f32 v180, v180
v_rcp_f32 v181, v181
v_rcp_f32 v182, v182
v_rcp_f32 v183, v183
v_pk_mul_f32 v[184:185], v[216:217], v[6:7] op_sel_hi:[1,0]
v_pk_mul_f32 v[186:187], v[218:219], v[6:7] op_sel_hi:[1,0]
v_pk_mul_f32 v[188:189], v[220:221], v[6:7] op_sel_hi:[1,0]
v_pk_mul_f32 v[190:191], v[222:223], v[6:7] op_sel_hi:[1,0]
v_pk_fma_f32 v[184:185], v[184:185], v[176:177], v[184:185] neg_lo:[1,0,0] neg_hi:[1,0,0]
v_pk_fma_f32 v[186:187], v[186:187], v[178:179], v[186:187] neg_lo:[1,0,0] neg_hi:[1,0,0]
v_pk_fma_f32 v[188:189], v[188:189], v[180:181], v[188:189] neg_lo:[1,0,0] neg_hi:[1,0,0]
v_pk_fma_f32 v[190:191], v[190:191], v[182:183], v[190:191] neg_lo:[1,0,0] neg_hi:[1,0,0]
v_cvt_pk_bf16_f32 v116, v184, v185
v_cvt_pk_bf16_f32 v117, v186, v187
v_cvt_pk_bf16_f32 v118, v188, v189
v_cvt_pk_bf16_f32 v119, v190, v191
ds_write_b128 v142, v[116:119] offset:17408
buffer_load_dwordx4 v15, s[68:71], s100 offen offset:1024 lds
buffer_load_dwordx4 v16, s[68:71], s100 offen offset:2048 lds
v_pk_fma_f32 v[176:177], v[192:193], s[34:35], -0.5 op_sel_hi:[1,0,0]
v_pk_fma_f32 v[178:179], v[194:195], s[34:35], -0.5 op_sel_hi:[1,0,0]
v_pk_fma_f32 v[180:181], v[196:197], s[34:35], -0.5 op_sel_hi:[1,0,0]
v_pk_fma_f32 v[182:183], v[198:199], s[34:35], -0.5 op_sel_hi:[1,0,0]
v_exp_f32 v176, v176
v_exp_f32 v177, v177
v_exp_f32 v178, v178
v_exp_f32 v179, v179
v_exp_f32 v180, v180
v_exp_f32 v181, v181
v_exp_f32 v182, v182
v_exp_f32 v183, v183
v_pk_add_f32 v[176:177], v[176:177], s[36:37] op_sel_hi:[1,0]
v_pk_add_f32 v[178:179], v[178:179], s[36:37] op_sel_hi:[1,0]
v_pk_add_f32 v[180:181], v[180:181], s[36:37] op_sel_hi:[1,0]
v_pk_add_f32 v[182:183], v[182:183], s[36:37] op_sel_hi:[1,0]
v_pk_fma_f32 v[176:177], v[176:177], v[176:177], 0.5 op_sel_hi:[1,1,0]
v_pk_fma_f32 v[178:179], v[178:179], v[178:179], 0.5 op_sel_hi:[1,1,0]
v_pk_fma_f32 v[180:181], v[180:181], v[180:181], 0.5 op_sel_hi:[1,1,0]
v_pk_fma_f32 v[182:183], v[182:183], v[182:183], 0.5 op_sel_hi:[1,1,0]
v_rcp_f32 v176, v176
v_rcp_f32 v177, v177
v_rcp_f32 v178, v178
v_rcp_f32 v179, v179
v_rcp_f32 v180, v180
v_rcp_f32 v181, v181
v_rcp_f32 v182, v182
v_rcp_f32 v183, v183
v_pk_mul_f32 v[184:185], v[192:193], v[4:5] op_sel_hi:[1,0]
v_pk_mul_f32 v[186:187], v[194:195], v[4:5] op_sel_hi:[1,0]
v_pk_mul_f32 v[188:189], v[196:197], v[4:5] op_sel_hi:[1,0]
v_pk_mul_f32 v[190:191], v[198:199], v[4:5] op_sel_hi:[1,0]
v_pk_fma_f32 v[184:185], v[184:185], v[176:177], v[184:185] neg_lo:[1,0,0] neg_hi:[1,0,0]
v_pk_fma_f32 v[186:187], v[186:187], v[178:179], v[186:187] neg_lo:[1,0,0] neg_hi:[1,0,0]
v_pk_fma_f32 v[188:189], v[188:189], v[180:181], v[188:189] neg_lo:[1,0,0] neg_hi:[1,0,0]
v_pk_fma_f32 v[190:191], v[190:191], v[182:183], v[190:191] neg_lo:[1,0,0] neg_hi:[1,0,0]
v_cvt_pk_bf16_f32 v112, v184, v185
v_cvt_pk_bf16_f32 v113, v186, v187
v_cvt_pk_bf16_f32 v114, v188, v189
v_cvt_pk_bf16_f32 v115, v190, v191
ds_write_b128 v142, v[112:115] offset:0
buffer_load_dwordx4 v17, s[68:71], s100 offen offset:3072 lds
s_add_u32 m0, s15, 16384
s_mov_b32 s100, s93
buffer_load_dwordx4 v18, s[72:75], s100 offen offset:0 lds
v_pk_fma_f32 v[176:177], v[200:201], s[34:35], -0.5 op_sel_hi:[1,0,0]
v_pk_fma_f32 v[178:179], v[202:203], s[34:35], -0.5 op_sel_hi:[1,0,0]
v_pk_fma_f32 v[180:181], v[204:205], s[34:35], -0.5 op_sel_hi:[1,0,0]
v_pk_fma_f32 v[182:183], v[206:207], s[34:35], -0.5 op_sel_hi:[1,0,0]
v_exp_f32 v176, v176
v_exp_f32 v177, v177
v_exp_f32 v178, v178
v_exp_f32 v179, v179
v_exp_f32 v180, v180
v_exp_f32 v181, v181
v_exp_f32 v182, v182
v_exp_f32 v183, v183
v_pk_add_f32 v[176:177], v[176:177], s[36:37] op_sel_hi:[1,0]
v_pk_add_f32 v[178:179], v[178:179], s[36:37] op_sel_hi:[1,0]
v_pk_add_f32 v[180:181], v[180:181], s[36:37] op_sel_hi:[1,0]
v_pk_add_f32 v[182:183], v[182:183], s[36:37] op_sel_hi:[1,0]
v_pk_fma_f32 v[176:177], v[176:177], v[176:177], 0.5 op_sel_hi:[1,1,0]
v_pk_fma_f32 v[178:179], v[178:179], v[178:179], 0.5 op_sel_hi:[1,1,0]
v_pk_fma_f32 v[180:181], v[180:181], v[180:181], 0.5 op_sel_hi:[1,1,0]
v_pk_fma_f32 v[182:183], v[182:183], v[182:183], 0.5 op_sel_hi:[1,1,0]
v_rcp_f32 v176, v176
v_rcp_f32 v177, v177
v_rcp_f32 v178, v178
v_rcp_f32 v179, v179
v_rcp_f32 v180, v180
v_rcp_f32 v181, v181
v_rcp_f32 v182, v182
v_rcp_f32 v183, v183
v_pk_mul_f32 v[184:185], v[200:201], v[4:5] op_sel_hi:[1,0]
v_pk_mul_f32 v[186:187], v[202:203], v[4:5] op_sel_hi:[1,0]
v_pk_mul_f32 v[188:189], v[204:205], v[4:5] op_sel_hi:[1,0]
v_pk_mul_f32 v[190:191], v[206:207], v[4:5] op_sel_hi:[1,0]
v_pk_fma_f32 v[184:185], v[184:185], v[176:177], v[184:185] neg_lo:[1,0,0] neg_hi:[1,0,0]
v_pk_fma_f32 v[186:187], v[186:187], v[178:179], v[186:187] neg_lo:[1,0,0] neg_hi:[1,0,0]
v_pk_fma_f32 v[188:189], v[188:189], v[180:181], v[188:189] neg_lo:[1,0,0] neg_hi:[1,0,0]
v_pk_fma_f32 v[190:191], v[190:191], v[182:183], v[190:191] neg_lo:[1,0,0] neg_hi:[1,0,0]
v_cvt_pk_bf16_f32 v116, v184, v185
v_cvt_pk_bf16_f32 v117, v186, v187
v_cvt_pk_bf16_f32 v118, v188, v189
v_cvt_pk_bf16_f32 v119, v190, v191
ds_write_b128 v142, v[116:119] offset:1024
buffer_load_dwordx4 v19, s[72:75], s100 offen offset:1024 lds
buffer_load_dwordx4 v20, s[72:75], s100 offen offset:2048 lds
buffer_load_dwordx4 v21, s[72:75], s100 offen offset:3072 lds
v_pk_fma_f32 v[176:177], v[240:241], s[34:35], -0.5 op_sel_hi:[1,0,0]
v_pk_fma_f32 v[178:179], v[242:243], s[34:35], -0.5 op_sel_hi:[1,0,0]
v_pk_fma_f32 v[180:181], v[244:245], s[34:35], -0.5 op_sel_hi:[1,0,0]
v_pk_fma_f32 v[182:183], v[246:247], s[34:35], -0.5 op_sel_hi:[1,0,0]
v_exp_f32 v176, v176
v_exp_f32 v177, v177
v_exp_f32 v178, v178
v_exp_f32 v179, v179
v_exp_f32 v180, v180
v_exp_f32 v181, v181
v_exp_f32 v182, v182
v_exp_f32 v183, v183
v_pk_add_f32 v[176:177], v[176:177], s[36:37] op_sel_hi:[1,0]
v_pk_add_f32 v[178:179], v[178:179], s[36:37] op_sel_hi:[1,0]
v_pk_add_f32 v[180:181], v[180:181], s[36:37] op_sel_hi:[1,0]
v_pk_add_f32 v[182:183], v[182:183], s[36:37] op_sel_hi:[1,0]
v_pk_fma_f32 v[176:177], v[176:177], v[176:177], 0.5 op_sel_hi:[1,1,0]
v_pk_fma_f32 v[178:179], v[178:179], v[178:179], 0.5 op_sel_hi:[1,1,0]
v_pk_fma_f32 v[180:181], v[180:181], v[180:181], 0.5 op_sel_hi:[1,1,0]
v_pk_fma_f32 v[182:183], v[182:183], v[182:183], 0.5 op_sel_hi:[1,1,0]
v_rcp_f32 v176, v176
v_rcp_f32 v177, v177
v_rcp_f32 v178, v178
v_rcp_f32 v179, v179
v_rcp_f32 v180, v180
v_rcp_f32 v181, v181
v_rcp_f32 v182, v182
v_rcp_f32 v183, v183
v_pk_mul_f32 v[184:185], v[240:241], v[6:7] op_sel_hi:[1,0]
v_pk_mul_f32 v[186:187], v[242:243], v[6:7] op_sel_hi:[1,0]
v_pk_mul_f32 v[188:189], v[244:245], v[6:7] op_sel_hi:[1,0]
v_pk_mul_f32 v[190:191], v[246:247], v[6:7] op_sel_hi:[1,0]
v_pk_fma_f32 v[184:185], v[184:185], v[176:177], v[184:185] neg_lo:[1,0,0] neg_hi:[1,0,0]
v_pk_fma_f32 v[186:187], v[186:187], v[178:179], v[186:187] neg_lo:[1,0,0] neg_hi:[1,0,0]
v_pk_fma_f32 v[188:189], v[188:189], v[180:181], v[188:189] neg_lo:[1,0,0] neg_hi:[1,0,0]
v_pk_fma_f32 v[190:191], v[190:191], v[182:183], v[190:191] neg_lo:[1,0,0] neg_hi:[1,0,0]
v_cvt_pk_bf16_f32 v112, v184, v185
v_cvt_pk_bf16_f32 v113, v186, v187
v_cvt_pk_bf16_f32 v114, v188, v189
v_cvt_pk_bf16_f32 v115, v190, v191
ds_write_b128 v142, v[112:115] offset:18432
s_waitcnt lgkmcnt(4) vmcnt(16)
s_barrier
s_add_u32 m0, s15, 147456
s_add_u32 s100, s93, 114688
buffer_load_dwordx4 v18, s[72:75], s100 offen offset:0 lds
buffer_load_dwordx4 v19, s[72:75], s100 offen offset:1024 lds
buffer_load_dwordx4 v20, s[72:75], s100 offen offset:2048 lds
ds_read_b64_tr_b16 a[224:225], v136 offset:0
ds_read_b64_tr_b16 a[226:227], v136 offset:512
ds_read_b64_tr_b16 a[228:229], v136 offset:2048
ds_read_b64_tr_b16 a[230:231], v136 offset:2560
ds_read_b64_tr_b16 a[232:233], v136 offset:4096
ds_read_b64_tr_b16 a[234:235], v136 offset:4608
ds_read_b64_tr_b16 a[236:237], v136 offset:6144
v_pk_fma_f32 v[176:177], v[248:249], s[34:35], -0.5 op_sel_hi:[1,0,0]
v_pk_fma_f32 v[178:179], v[250:251], s[34:35], -0.5 op_sel_hi:[1,0,0]
v_pk_fma_f32 v[180:181], v[252:253], s[34:35], -0.5 op_sel_hi:[1,0,0]
v_pk_fma_f32 v[182:183], v[254:255], s[34:35], -0.5 op_sel_hi:[1,0,0]
v_exp_f32 v176, v176
v_exp_f32 v177, v177
v_exp_f32 v178, v178
v_exp_f32 v179, v179
v_exp_f32 v180, v180
v_exp_f32 v181, v181
v_exp_f32 v182, v182
v_exp_f32 v183, v183
v_pk_add_f32 v[176:177], v[176:177], s[36:37] op_sel_hi:[1,0]
v_pk_add_f32 v[178:179], v[178:179], s[36:37] op_sel_hi:[1,0]
v_pk_add_f32 v[180:181], v[180:181], s[36:37] op_sel_hi:[1,0]
v_pk_add_f32 v[182:183], v[182:183], s[36:37] op_sel_hi:[1,0]
v_pk_fma_f32 v[176:177], v[176:177], v[176:177], 0.5 op_sel_hi:[1,1,0]
v_pk_fma_f32 v[178:179], v[178:179], v[178:179], 0.5 op_sel_hi:[1,1,0]
v_pk_fma_f32 v[180:181], v[180:181], v[180:181], 0.5 op_sel_hi:[1,1,0]
v_pk_fma_f32 v[182:183], v[182:183], v[182:183], 0.5 op_sel_hi:[1,1,0]
v_rcp_f32 v176, v176
v_rcp_f32 v177, v177
v_rcp_f32 v178, v178
v_rcp_f32 v179, v179
v_rcp_f32 v180, v180
v_rcp_f32 v181, v181
v_rcp_f32 v182, v182
v_rcp_f32 v183, v183
v_pk_mul_f32 v[184:185], v[248:249], v[6:7] op_sel_hi:[1,0]
v_pk_mul_f32 v[186:187], v[250:251], v[6:7] op_sel_hi:[1,0]
v_pk_mul_f32 v[188:189], v[252:253], v[6:7] op_sel_hi:[1,0]
v_pk_mul_f32 v[190:191], v[254:255], v[6:7] op_sel_hi:[1,0]
v_pk_fma_f32 v[184:185], v[184:185], v[176:177], v[184:185] neg_lo:[1,0,0] neg_hi:[1,0,0]
v_pk_fma_f32 v[186:187], v[186:187], v[178:179], v[186:187] neg_lo:[1,0,0] neg_hi:[1,0,0]
v_pk_fma_f32 v[188:189], v[188:189], v[180:181], v[188:189] neg_lo:[1,0,0] neg_hi:[1,0,0]
v_pk_fma_f32 v[190:191], v[190:191], v[182:183], v[190:191] neg_lo:[1,0,0] neg_hi:[1,0,0]
v_cvt_pk_bf16_f32 v116, v184, v185
v_cvt_pk_bf16_f32 v117, v186, v187
v_cvt_pk_bf16_f32 v118, v188, v189
v_cvt_pk_bf16_f32 v119, v190, v191
ds_write_b128 v142, v[116:119] offset:19456
buffer_load_dwordx4 v21, s[72:75], s100 offen offset:3072 lds
s_add_u32 m0, s15, 32768
s_mul_i32 s100, s94, 448
buffer_load_dwordx4 v14, s[68:71], s100 offen offset:0 lds
buffer_load_dwordx4 v15, s[68:71], s100 offen offset:1024 lds
ds_read_b64_tr_b16 a[238:239], v136 offset:6656
ds_read_b64_tr_b16 a[240:241], v136 offset:8192
ds_read_b64_tr_b16 a[242:243], v136 offset:8704
ds_read_b64_tr_b16 a[244:245], v136 offset:10240
ds_read_b64_tr_b16 a[246:247], v136 offset:10752
ds_read_b64_tr_b16 a[248:249], v136 offset:12288
ds_read_b64_tr_b16 a[250:251], v136 offset:12800
v_pk_fma_f32 v[176:177], v[224:225], s[34:35], -0.5 op_sel_hi:[1,0,0]
v_pk_fma_f32 v[178:179], v[226:227], s[34:35], -0.5 op_sel_hi:[1,0,0]
v_pk_fma_f32 v[180:181], v[228:229], s[34:35], -0.5 op_sel_hi:[1,0,0]
v_pk_fma_f32 v[182:183], v[230:231], s[34:35], -0.5 op_sel_hi:[1,0,0]
v_exp_f32 v176, v176
v_exp_f32 v177, v177
v_exp_f32 v178, v178
v_exp_f32 v179, v179
v_exp_f32 v180, v180
v_exp_f32 v181, v181
v_exp_f32 v182, v182
v_exp_f32 v183, v183
v_pk_add_f32 v[176:177], v[176:177], s[36:37] op_sel_hi:[1,0]
v_pk_add_f32 v[178:179], v[178:179], s[36:37] op_sel_hi:[1,0]
v_pk_add_f32 v[180:181], v[180:181], s[36:37] op_sel_hi:[1,0]
v_pk_add_f32 v[182:183], v[182:183], s[36:37] op_sel_hi:[1,0]
v_pk_fma_f32 v[176:177], v[176:177], v[176:177], 0.5 op_sel_hi:[1,1,0]
v_pk_fma_f32 v[178:179], v[178:179], v[178:179], 0.5 op_sel_hi:[1,1,0]
v_pk_fma_f32 v[180:181], v[180:181], v[180:181], 0.5 op_sel_hi:[1,1,0]
v_pk_fma_f32 v[182:183], v[182:183], v[182:183], 0.5 op_sel_hi:[1,1,0]
v_rcp_f32 v176, v176
v_rcp_f32 v177, v177
v_rcp_f32 v178, v178
v_rcp_f32 v179, v179
v_rcp_f32 v180, v180
v_rcp_f32 v181, v181
v_rcp_f32 v182, v182
v_rcp_f32 v183, v183
v_pk_mul_f32 v[184:185], v[224:225], v[4:5] op_sel_hi:[1,0]
v_pk_mul_f32 v[186:187], v[226:227], v[4:5] op_sel_hi:[1,0]
v_pk_mul_f32 v[188:189], v[228:229], v[4:5] op_sel_hi:[1,0]
v_pk_mul_f32 v[190:191], v[230:231], v[4:5] op_sel_hi:[1,0]
v_pk_fma_f32 v[184:185], v[184:185], v[176:177], v[184:185] neg_lo:[1,0,0] neg_hi:[1,0,0]
v_pk_fma_f32 v[186:187], v[186:187], v[178:179], v[186:187] neg_lo:[1,0,0] neg_hi:[1,0,0]
v_pk_fma_f32 v[188:189], v[188:189], v[180:181], v[188:189] neg_lo:[1,0,0] neg_hi:[1,0,0]
v_pk_fma_f32 v[190:191], v[190:191], v[182:183], v[190:191] neg_lo:[1,0,0] neg_hi:[1,0,0]
v_cvt_pk_bf16_f32 v112, v184, v185
v_cvt_pk_bf16_f32 v113, v186, v187
v_cvt_pk_bf16_f32 v114, v188, v189
v_cvt_pk_bf16_f32 v115, v190, v191
ds_write_b128 v142, v[112:115] offset:2048
buffer_load_dwordx4 v16, s[68:71], s100 offen offset:2048 lds
buffer_load_dwordx4 v17, s[68:71], s100 offen offset:3072 lds
ds_read_b64_tr_b16 a[252:253], v136 offset:14336
ds_read_b64_tr_b16 a[254:255], v136 offset:14848
ds_read_b128 a[64:67], v140 offset:49152
ds_read_b128 a[68:71], v23 offset:49152
ds_read_b128 a[72:75], v24 offset:49152
ds_read_b128 a[76:79], v25 offset:49152
v_pk_fma_f32 v[176:177], v[232:233], s[34:35], -0.5 op_sel_hi:[1,0,0]
v_pk_fma_f32 v[178:179], v[234:235], s[34:35], -0.5 op_sel_hi:[1,0,0]
v_pk_fma_f32 v[180:181], v[236:237], s[34:35], -0.5 op_sel_hi:[1,0,0]
v_pk_fma_f32 v[182:183], v[238:239], s[34:35], -0.5 op_sel_hi:[1,0,0]
v_exp_f32 v176, v176
v_exp_f32 v177, v177
v_exp_f32 v178, v178
v_exp_f32 v179, v179
v_exp_f32 v180, v180
v_exp_f32 v181, v181
v_exp_f32 v182, v182
v_exp_f32 v183, v183
v_pk_add_f32 v[176:177], v[176:177], s[36:37] op_sel_hi:[1,0]
v_pk_add_f32 v[178:179], v[178:179], s[36:37] op_sel_hi:[1,0]
v_pk_add_f32 v[180:181], v[180:181], s[36:37] op_sel_hi:[1,0]
v_pk_add_f32 v[182:183], v[182:183], s[36:37] op_sel_hi:[1,0]
v_pk_fma_f32 v[176:177], v[176:177], v[176:177], 0.5 op_sel_hi:[1,1,0]
v_pk_fma_f32 v[178:179], v[178:179], v[178:179], 0.5 op_sel_hi:[1,1,0]
v_pk_fma_f32 v[180:181], v[180:181], v[180:181], 0.5 op_sel_hi:[1,1,0]
v_pk_fma_f32 v[182:183], v[182:183], v[182:183], 0.5 op_sel_hi:[1,1,0]
v_rcp_f32 v176, v176
v_rcp_f32 v177, v177
v_rcp_f32 v178, v178
v_rcp_f32 v179, v179
v_rcp_f32 v180, v180
v_rcp_f32 v181, v181
v_rcp_f32 v182, v182
v_rcp_f32 v183, v183
v_pk_mul_f32 v[184:185], v[232:233], v[4:5] op_sel_hi:[1,0]
v_pk_mul_f32 v[186:187], v[234:235], v[4:5] op_sel_hi:[1,0]
v_pk_mul_f32 v[188:189], v[236:237], v[4:5] op_sel_hi:[1,0]
v_pk_mul_f32 v[190:191], v[238:239], v[4:5] op_sel_hi:[1,0]
v_pk_fma_f32 v[184:185], v[184:185], v[176:177], v[184:185] neg_lo:[1,0,0] neg_hi:[1,0,0]
v_pk_fma_f32 v[186:187], v[186:187], v[178:179], v[186:187] neg_lo:[1,0,0] neg_hi:[1,0,0]
v_pk_fma_f32 v[188:189], v[188:189], v[180:181], v[188:189] neg_lo:[1,0,0] neg_hi:[1,0,0]
v_pk_fma_f32 v[190:191], v[190:191], v[182:183], v[190:191] neg_lo:[1,0,0] neg_hi:[1,0,0]
v_cvt_pk_bf16_f32 v116, v184, v185
v_cvt_pk_bf16_f32 v117, v186, v187
v_cvt_pk_bf16_f32 v118, v188, v189
v_cvt_pk_bf16_f32 v119, v190, v191
ds_write_b128 v142, v[116:119] offset:3072
s_waitcnt lgkmcnt(4)
v_mfma_f32_32x32x16_bf16 v[192:207], a[224:227], a[64:67], 0
ds_read_b128 a[80:83], v26 offset:49152
ds_read_b128 a[84:87], v27 offset:49152
ds_read_b128 a[88:91], v28 offset:49152
s_waitcnt lgkmcnt(6)
v_mfma_f32_32x32x16_bf16 v[192:207], a[228:231], a[68:71], v[192:207]
s_waitcnt lgkmcnt(3) vmcnt(20)
s_barrier
ds_read_b128 a[0:3], v143 offset:0
v_mfma_f32_32x32x16_bf16 v[192:207], a[232:235], a[72:75], v[192:207]
s_add_u32 m0, s15, 98304
s_mov_b32 s100, s94
buffer_load_dwordx4 v18, s[72:75], s100 offen offset:0 lds
ds_read_b128 a[4:7], v143 offset:1024
v_mfma_f32_32x32x16_bf16 v[192:207], a[236:239], a[76:79], v[192:207]
buffer_load_dwordx4 v19, s[72:75], s100 offen offset:1024 lds
ds_read_b128 a[8:11], v143 offset:2048
ds_read_b128 a[92:95], v29 offset:49152
s_waitcnt lgkmcnt(5)
v_mfma_f32_32x32x16_bf16 v[192:207], a[240:243], a[80:83], v[192:207]
ds_read_b128 a[12:15], v143 offset:3072
ds_read_b64_tr_b16 a[96:97], v45 offset:0
ds_read_b64_tr_b16 a[98:99], v45 offset:512
v_mfma_f32_32x32x16_bf16 v[192:207], a[244:247], a[84:87], v[192:207]
buffer_load_dwordx4 v20, s[72:75], s100 offen offset:2048 lds
ds_read_b128 a[16:19], v143 offset:4096
ds_read_b64_tr_b16 a[100:101], v45 offset:1024
ds_read_b64_tr_b16 a[102:103], v45 offset:1536
s_waitcnt lgkmcnt(6)
v_mfma_f32_32x32x16_bf16 v[192:207], a[248:251], a[88:91], v[192:207]
ds_read_b128 a[20:23], v143 offset:5120
ds_read_b64_tr_b16 a[64:65], v45 offset:4096
ds_read_b64_tr_b16 a[66:67], v45 offset:4608
v_mfma_f32_32x32x16_bf16 v[192:207], a[252:255], a[92:95], v[192:207]
buffer_load_dwordx4 v21, s[72:75], s100 offen offset:3072 lds
ds_read_b128 a[24:27], v143 offset:6144
ds_read_b64_tr_b16 a[68:69], v45 offset:5120
ds_read_b64_tr_b16 a[70:71], v45 offset:5632
s_waitcnt lgkmcnt(6)
v_mfma_f32_32x32x16_bf16 v[192:207], a[0:3], a[96:99], v[192:207]
ds_read_b128 a[28:31], v143 offset:7168
ds_read_b64_tr_b16 a[72:73], v45 offset:8192
ds_read_b64_tr_b16 a[74:75], v45 offset:8704
v_mfma_f32_32x32x16_bf16 v[192:207], a[4:7], a[100:103], v[192:207]
ds_read_b128 a[32:35], v143 offset:8192
ds_read_b64_tr_b16 a[76:77], v45 offset:9216
ds_read_b64_tr_b16 a[78:79], v45 offset:9728
s_waitcnt lgkmcnt(6)
v_mfma_f32_32x32x16_bf16 v[192:207], a[8:11], a[64:67], v[192:207]
ds_read_b128 a[36:39], v143 offset:9216
ds_read_b64_tr_b16 a[80:81], v45 offset:12288
ds_read_b64_tr_b16 a[82:83], v45 offset:12800
v_mfma_f32_32x32x16_bf16 v[192:207], a[12:15], a[68:71], v[192:207]
s_waitcnt vmcnt(20)
s_barrier
ds_read_b128 a[40:43], v143 offset:10240
ds_read_b64_tr_b16 a[84:85], v45 offset:13312
ds_read_b64_tr_b16 a[86:87], v45 offset:13824
s_waitcnt lgkmcnt(6)
v_mfma_f32_32x32x16_bf16 v[192:207], a[16:19], a[72:75], v[192:207]
s_add_u32 m0, s15, 49152
s_add_u32 s100, s94, 114688
buffer_load_dwordx4 v18, s[72:75], s100 offen offset:0 lds
ds_read_b128 a[44:47], v143 offset:11264
ds_read_b64_tr_b16 a[88:89], v45 offset:16384
ds_read_b64_tr_b16 a[90:91], v45 offset:16896
v_mfma_f32_32x32x16_bf16 v[192:207], a[20:23], a[76:79], v[192:207]
buffer_load_dwordx4 v19, s[72:75], s100 offen offset:1024 lds
ds_read_b128 a[48:51], v143 offset:12288
ds_read_b64_tr_b16 a[92:93], v45 offset:17408
ds_read_b64_tr_b16 a[94:95], v45 offset:17920
s_waitcnt lgkmcnt(6)
v_mfma_f32_32x32x16_bf16 v[192:207], a[24:27], a[80:83], v[192:207]
ds_read_b128 a[52:55], v143 offset:13312
ds_read_b64_tr_b16 a[96:97], v45 offset:20480
ds_read_b64_tr_b16 a[98:99], v45 offset:20992
v_mfma_f32_32x32x16_bf16 v[192:207], a[28:31], a[84:87], v[192:207]
buffer_load_dwordx4 v20, s[72:75], s100 offen offset:2048 lds
ds_read_b128 a[56:59], v143 offset:14336
ds_read_b64_tr_b16 a[100:101], v45 offset:21504
ds_read_b64_tr_b16 a[102:103], v45 offset:22016
s_waitcnt lgkmcnt(6)
v_mfma_f32_32x32x16_bf16 v[192:207], a[32:35], a[88:91], v[192:207]
ds_read_b64_tr_b16 a[64:65], v45 offset:24576
ds_read_b64_tr_b16 a[66:67], v45 offset:25088
buffer_load_dwordx4 v21, s[72:75], s100 offen offset:3072 lds
v_mfma_f32_32x32x16_bf16 v[192:207], a[36:39], a[92:95], v[192:207]
ds_read_b128 a[60:63], v143 offset:15360
ds_read_b64_tr_b16 a[68:69], v45 offset:25600
ds_read_b64_tr_b16 a[70:71], v45 offset:26112
s_waitcnt lgkmcnt(5)
v_mfma_f32_32x32x16_bf16 v[192:207], a[40:43], a[96:99], v[192:207]
ds_read_b64_tr_b16 a[72:73], v45 offset:28672
ds_read_b64_tr_b16 a[74:75], v45 offset:29184
v_cmp_ne_u32 vcc, s83, v42
s_cbranch_vccnz L_mode
L_near:
v_mfma_f32_32x32x16_bf16 v[192:207], a[44:47], a[100:103], v[192:207]
s_waitcnt lgkmcnt(4) vmcnt(20)
s_barrier
ds_read_b64_tr_b16 a[76:77], v45 offset:29696
ds_read_b64_tr_b16 a[78:79], v45 offset:30208
s_waitcnt lgkmcnt(4)
v_mfma_f32_32x32x16_bf16 v[192:207], a[48:51], a[64:67], v[192:207]
s_add_u32 m0, s15, 114688
s_mul_i32 s100, s95, 448
buffer_load_dwordx4 v14, s[68:71], s100 offen offset:0 lds
ds_read_b128 a[80:83], v140 offset:0
v_mfma_f32_32x32x16_bf16 v[192:207], a[52:55], a[68:71], v[192:207]
buffer_load_dwordx4 v15, s[68:71], s100 offen offset:1024 lds
ds_read_b128 a[84:87], v23 offset:0
s_waitcnt lgkmcnt(2)
v_mfma_f32_32x32x16_bf16 v[192:207], a[56:59], a[72:75], v[192:207]
ds_read_b128 a[88:91], v24 offset:0
buffer_load_dwordx4 v16, s[68:71], s100 offen offset:2048 lds
ds_read_b128 a[92:95], v25 offset:0
v_mfma_f32_32x32x16_bf16 v[192:207], a[60:63], a[76:79], v[192:207]
ds_read_b128 a[96:99], v26 offset:0
ds_read_b128 a[100:103], v27 offset:0
ds_read_b128 a[64:67], v28 offset:0
s_waitcnt lgkmcnt(5)
v_mfma_f32_32x32x16_bf16 v[208:223], a[224:227], a[80:83], 0
buffer_load_dwordx4 v17, s[68:71], s100 offen offset:3072 lds
ds_read_b128 a[68:71], v29 offset:0
v_mfma_f32_32x32x16_bf16 v[208:223], a[228:231], a[84:87], v[208:223]
v_cvt_pk_bf16_f32 v176, v192, v193
v_bitop3_b32 v176, s82, v105, v176 bitop3:202
v_cvt_pk_bf16_f32 v177, v194, v195
s_lshl_b32 s50, s92, 1
v_bitop3_b32 v177, s82, v105, v177 bitop3:58
s_waitcnt lgkmcnt(4)
v_mfma_f32_32x32x16_bf16 v[208:223], a[232:235], a[88:91], v[208:223]
v_cvt_pk_bf16_f32 v178, v196, v197
v_bitop3_b32 v178, s82, v105, v178 bitop3:202
v_cvt_pk_bf16_f32 v179, v198, v199
v_bitop3_b32 v179, s82, v105, v179 bitop3:58
v_cvt_pk_bf16_f32 v180, v200, v201
v_bitop3_b32 v180, s82, v105, v180 bitop3:202
v_mfma_f32_32x32x16_bf16 v[208:223], a[236:239], a[92:95], v[208:223]
s_waitcnt vmcnt(20)
s_barrier
buffer_store_dwordx4 v[176:179], v108, s[88:91], s50 offen
s_waitcnt lgkmcnt(2)
v_mfma_f32_32x32x16_bf16 v[208:223], a[240:243], a[96:99], v[208:223]
ds_read_b64_tr_b16 a[72:73], v139 offset:16384
ds_read_b64_tr_b16 a[74:75], v139 offset:16896
ds_read_b64_tr_b16 a[76:77], v139 offset:17408
ds_read_b64_tr_b16 a[78:79], v139 offset:17920
v_cvt_pk_bf16_f32 v181, v202, v203
v_bitop3_b32 v181, s82, v105, v181 bitop3:58
v_cvt_pk_bf16_f32 v182, v204, v205
v_bitop3_b32 v182, s82, v105, v182 bitop3:202
v_cvt_pk_bf16_f32 v183, v206, v207
v_bitop3_b32 v183, s82, v105, v183 bitop3:58
v_mfma_f32_32x32x16_bf16 v[208:223], a[244:247], a[100:103], v[208:223]
buffer_store_dwordx4 v[180:183], v109, s[88:91], s50 offen
s_waitcnt lgkmcnt(4)
v_mfma_f32_32x32x16_bf16 v[208:223], a[248:251], a[64:67], v[208:223]
ds_read_b64_tr_b16 a[80:81], v139 offset:20480
ds_read_b64_tr_b16 a[82:83], v139 offset:20992
ds_read_b64_tr_b16 a[84:85], v139 offset:21504
v_mfma_f32_32x32x16_bf16 v[208:223], a[252:255], a[68:71], v[208:223]
ds_read_b64_tr_b16 a[86:87], v139 offset:22016
ds_read_b64_tr_b16 a[88:89], v139 offset:24576
ds_read_b64_tr_b16 a[90:91], v139 offset:25088
s_waitcnt lgkmcnt(6)
v_mfma_f32_32x32x16_bf16 v[208:223], a[0:3], a[72:75], v[208:223]
s_add_u32 m0, s15, 131072
s_mov_b32 s100, s95
buffer_load_dwordx4 v18, s[72:75], s100 offen offset:0 lds
ds_read_b64_tr_b16 a[92:93], v139 offset:25600
v_mfma_f32_32x32x16_bf16 v[208:223], a[4:7], a[76:79], v[208:223]
ds_read_b64_tr_b16 a[94:95], v139 offset:26112
ds_read_b64_tr_b16 a[96:97], v139 offset:28672
ds_read_b64_tr_b16 a[98:99], v139 offset:29184
s_waitcnt lgkmcnt(6)
v_mfma_f32_32x32x16_bf16 v[208:223], a[8:11], a[80:83], v[208:223]
buffer_load_dwordx4 v19, s[72:75], s100 offen offset:1024 lds
ds_read_b64_tr_b16 a[100:101], v139 offset:29696
ds_read_b64_tr_b16 a[102:103], v139 offset:30208
v_mfma_f32_32x32x16_bf16 v[208:223], a[12:15], a[84:87], v[208:223]
s_waitcnt vmcnt(20)
s_barrier
buffer_load_dwordx4 v20, s[72:75], s100 offen offset:2048 lds
s_waitcnt lgkmcnt(4)
v_mfma_f32_32x32x16_bf16 v[208:223], a[16:19], a[88:91], v[208:223]
ds_read_b64_tr_b16 a[64:65], v46 offset:16384
ds_read_b64_tr_b16 a[66:67], v46 offset:16896
ds_read_b64_tr_b16 a[68:69], v46 offset:17408
v_mfma_f32_32x32x16_bf16 v[208:223], a[20:23], a[92:95], v[208:223]
ds_read_b64_tr_b16 a[70:71], v46 offset:17920
buffer_load_dwordx4 v21, s[72:75], s100 offen offset:3072 lds
s_waitcnt lgkmcnt(4)
v_mfma_f32_32x32x16_bf16 v[208:223], a[24:27], a[96:99], v[208:223]
ds_read_b64_tr_b16 a[72:73], v46 offset:20480
ds_read_b64_tr_b16 a[74:75], v46 offset:20992
ds_read_b64_tr_b16 a[76:77], v46 offset:21504
v_mfma_f32_32x32x16_bf16 v[208:223], a[28:31], a[100:103], v[208:223]
ds_read_b64_tr_b16 a[78:79], v46 offset:22016
ds_read_b64_tr_b16 a[80:81], v46 offset:24576
ds_read_b64_tr_b16 a[82:83], v46 offset:25088
s_waitcnt lgkmcnt(6)
v_mfma_f32_32x32x16_bf16 v[208:223], a[32:35], a[64:67], v[208:223]
s_add_u32 m0, s15, 65536
s_add_u32 s100, s95, 114688
buffer_load_dwordx4 v18, s[72:75], s100 offen offset:0 lds
ds_read_b64_tr_b16 a[84:85], v46 offset:25600
v_mfma_f32_32x32x16_bf16 v[208:223], a[36:39], a[68:71], v[208:223]
ds_read_b64_tr_b16 a[86:87], v46 offset:26112
buffer_load_dwordx4 v19, s[72:75], s100 offen offset:1024 lds
s_waitcnt lgkmcnt(4)
v_mfma_f32_32x32x16_bf16 v[208:223], a[40:43], a[72:75], v[208:223]
ds_read_b64_tr_b16 a[88:89], v46 offset:28672
ds_read_b64_tr_b16 a[90:91], v46 offset:29184
ds_read_b64_tr_b16 a[92:93], v46 offset:29696
v_mfma_f32_32x32x16_bf16 v[208:223], a[44:47], a[76:79], v[208:223]
s_waitcnt vmcnt(20)
s_barrier
ds_read_b64_tr_b16 a[94:95], v46 offset:30208
s_waitcnt lgkmcnt(4)
v_mfma_f32_32x32x16_bf16 v[208:223], a[48:51], a[80:83], v[208:223]
buffer_load_dwordx4 v20, s[72:75], s100 offen offset:2048 lds
ds_read_b128 a[96:99], v140 offset:32768
ds_read_b128 a[100:103], v23 offset:32768
v_mfma_f32_32x32x16_bf16 v[208:223], a[52:55], a[84:87], v[208:223]
buffer_load_dwordx4 v21, s[72:75], s100 offen offset:3072 lds
ds_read_b128 a[64:67], v24 offset:32768
s_waitcnt lgkmcnt(3)
v_mfma_f32_32x32x16_bf16 v[208:223], a[56:59], a[88:91], v[208:223]
s_add_u32 m0, s15, 81920
s_mul_i32 s100, s96, 448
buffer_load_dwordx4 v14, s[68:71], s100 offen offset:0 lds
ds_read_b128 a[68:71], v25 offset:32768
v_mfma_f32_32x32x16_bf16 v[208:223], a[60:63], a[92:95], v[208:223]
ds_read_b128 a[72:75], v26 offset:32768
ds_read_b128 a[76:79], v27 offset:32768
ds_read_b128 a[80:83], v28 offset:32768
s_waitcnt lgkmcnt(5)
v_mfma_f32_32x32x16_bf16 v[192:207], a[224:227], a[96:99], 0
s_lshl_b32 s13, s94, 1
buffer_load_dwordx4 v[112:115], v108, s[88:91], s13 offen sc1
buffer_load_dwordx4 v[116:119], v109, s[88:91], s13 offen sc1
v_mfma_f32_32x32x16_bf16 v[192:207], a[228:231], a[100:103], v[192:207]
ds_read_b128 a[84:87], v29 offset:32768
v_cvt_pk_bf16_f32 v176, v208, v209
v_bitop3_b32 v176, s82, v105, v176 bitop3:202
v_cvt_pk_bf16_f32 v177, v210, v211
s_lshl1_add_u32 s50, s93, 57344
s_waitcnt lgkmcnt(4)
v_mfma_f32_32x32x16_bf16 v[192:207], a[232:235], a[64:67], v[192:207]
v_bitop3_b32 v177, s82, v105, v177 bitop3:58
v_cvt_pk_bf16_f32 v178, v212, v213
v_bitop3_b32 v178, s82, v105, v178 bitop3:202
v_cvt_pk_bf16_f32 v179, v214, v215
v_bitop3_b32 v179, s82, v105, v179 bitop3:58
v_cvt_pk_bf16_f32 v180, v216, v217
v_mfma_f32_32x32x16_bf16 v[192:207], a[236:239], a[68:71], v[192:207]
s_waitcnt vmcnt(21)
s_barrier
buffer_store_dwordx4 v[176:179], v108, s[88:91], s50 offen
s_waitcnt lgkmcnt(2)
v_mfma_f32_32x32x16_bf16 v[192:207], a[240:243], a[72:75], v[192:207]
ds_read_b64_tr_b16 a[88:89], v45 offset:32768
ds_read_b64_tr_b16 a[90:91], v45 offset:33280
ds_read_b64_tr_b16 a[92:93], v45 offset:33792
ds_read_b64_tr_b16 a[94:95], v45 offset:34304
v_bitop3_b32 v180, s82, v105, v180 bitop3:202
v_cvt_pk_bf16_f32 v181, v218, v219
v_bitop3_b32 v181, s82, v105, v181 bitop3:58
v_cvt_pk_bf16_f32 v182, v220, v221
v_bitop3_b32 v182, s82, v105, v182 bitop3:202
v_cvt_pk_bf16_f32 v183, v222, v223
v_bitop3_b32 v183, s82, v105, v183 bitop3:58
v_mfma_f32_32x32x16_bf16 v[192:207], a[244:247], a[76:79], v[192:207]
buffer_store_dwordx4 v[180:183], v109, s[88:91], s50 offen
s_waitcnt lgkmcnt(4)
v_mfma_f32_32x32x16_bf16 v[192:207], a[248:251], a[80:83], v[192:207]
ds_read_b64_tr_b16 a[96:97], v45 offset:36864
ds_read_b64_tr_b16 a[98:99], v45 offset:37376
ds_read_b64_tr_b16 a[100:101], v45 offset:37888
v_mfma_f32_32x32x16_bf16 v[192:207], a[252:255], a[84:87], v[192:207]
ds_read_b64_tr_b16 a[102:103], v45 offset:38400
ds_read_b64_tr_b16 a[64:65], v45 offset:40960
ds_read_b64_tr_b16 a[66:67], v45 offset:41472
s_waitcnt lgkmcnt(6)
v_mfma_f32_32x32x16_bf16 v[192:207], a[0:3], a[88:91], v[192:207]
ds_read_b64_tr_b16 a[68:69], v45 offset:41984
ds_read_b64_tr_b16 a[70:71], v45 offset:42496
ds_read_b64_tr_b16 a[72:73], v45 offset:45056
v_mfma_f32_32x32x16_bf16 v[192:207], a[4:7], a[92:95], v[192:207]
buffer_load_dwordx4 v15, s[68:71], s100 offen offset:1024 lds
ds_read_b64_tr_b16 a[74:75], v45 offset:45568
s_waitcnt lgkmcnt(6)
v_mfma_f32_32x32x16_bf16 v[192:207], a[8:11], a[96:99], v[192:207]
ds_read_b64_tr_b16 a[76:77], v45 offset:46080
ds_read_b64_tr_b16 a[78:79], v45 offset:46592
v_mfma_f32_32x32x16_bf16 v[192:207], a[12:15], a[100:103], v[192:207]
s_waitcnt vmcnt(20)
s_barrier
buffer_load_dwordx4 v16, s[68:71], s100 offen offset:2048 lds
s_waitcnt lgkmcnt(4)
v_mfma_f32_32x32x16_bf16 v[192:207], a[16:19], a[64:67], v[192:207]
ds_read_b64_tr_b16 a[80:81], v139 offset:49152
ds_read_b64_tr_b16 a[82:83], v139 offset:49664
buffer_load_dwordx4 v17, s[68:71], s100 offen offset:3072 lds
v_mfma_f32_32x32x16_bf16 v[192:207], a[20:23], a[68:71], v[192:207]
ds_read_b64_tr_b16 a[84:85], v139 offset:50176
ds_read_b64_tr_b16 a[86:87], v139 offset:50688
ds_read_b64_tr_b16 a[88:89], v139 offset:53248
s_waitcnt lgkmcnt(5)
v_mfma_f32_32x32x16_bf16 v[192:207], a[24:27], a[72:75], v[192:207]
ds_read_b64_tr_b16 a[90:91], v139 offset:53760
s_add_u32 m0, s15, 0
s_mov_b32 s100, s96
buffer_load_dwordx4 v18, s[72:75], s100 offen offset:0 lds
v_mfma_f32_32x32x16_bf16 v[192:207], a[28:31], a[76:79], v[192:207]
ds_read_b64_tr_b16 a[92:93], v139 offset:54272
ds_read_b64_tr_b16 a[94:95], v139 offset:54784
ds_read_b64_tr_b16 a[96:97], v139 offset:57344
s_waitcnt lgkmcnt(5)
v_mfma_f32_32x32x16_bf16 v[192:207], a[32:35], a[80:83], v[192:207]
ds_read_b64_tr_b16 a[98:99], v139 offset:57856
buffer_load_dwordx4 v19, s[72:75], s100 offen offset:1024 lds
ds_read_b64_tr_b16 a[100:101], v139 offset:58368
v_mfma_f32_32x32x16_bf16 v[192:207], a[36:39], a[84:87], v[192:207]
ds_read_b64_tr_b16 a[102:103], v139 offset:58880
ds_read_b64_tr_b16 a[64:65], v139 offset:61440
ds_read_b64_tr_b16 a[66:67], v139 offset:61952
s_waitcnt lgkmcnt(6)
v_mfma_f32_32x32x16_bf16 v[192:207], a[40:43], a[88:91], v[192:207]
buffer_load_dwordx4 v20, s[72:75], s100 offen offset:2048 lds
ds_read_b64_tr_b16 a[68:69], v139 offset:62464
ds_read_b64_tr_b16 a[70:71], v139 offset:62976
v_mfma_f32_32x32x16_bf16 v[192:207], a[44:47], a[92:95], v[192:207]
buffer_load_dwordx4 v21, s[72:75], s100 offen offset:3072 lds
s_waitcnt lgkmcnt(4)
v_mfma_f32_32x32x16_bf16 v[192:207], a[48:51], a[96:99], v[192:207]
s_waitcnt vmcnt(10)
v_bitop3_b32 v60, v105, v112, v113 bitop3:0xbd
v_bitop3_b32 v120, v105, v114, v115 bitop3:0xbd
s_waitcnt vmcnt(9)
v_bitop3_b32 v121, v105, v116, v117 bitop3:0xbd
v_bitop3_b32 v59, v105, v118, v119 bitop3:0xbd
v_mfma_f32_32x32x16_bf16 v[192:207], a[52:55], a[100:103], v[192:207]
s_barrier
v_or3_b32 v60, v60, v120, v121
v_bitop3_b32 v60, v60, v59, s82 bitop3:0xa8
v_cmp_ne_u32 vcc, 0, v60
s_cbranch_vccnz L_rp0
L_bp0:
v_mfma_f32_32x32x16_bf16 v[192:207], v[96:99], v[112:115], v[192:207]
s_add_u32 m0, s15, 16384
s_add_u32 s100, s96, 114688
buffer_load_dwordx4 v18, s[72:75], s100 offen offset:0 lds
ds_read_b128 a[72:75], v30 offset:49152
v_mfma_f32_32x32x16_bf16 v[192:207], v[100:103], v[116:119], v[192:207]
ds_read_b128 a[76:79], v31 offset:49152
buffer_load_dwordx4 v19, s[72:75], s100 offen offset:1024 lds
s_waitcnt lgkmcnt(2)
v_mfma_f32_32x32x16_bf16 v[192:207], a[56:59], a[64:67], v[192:207]
ds_read_b128 a[80:83], v32 offset:49152
ds_read_b128 a[84:87], v33 offset:49152
ds_read_b128 a[88:91], v34 offset:49152
v_mfma_f32_32x32x16_bf16 v[192:207], a[60:63], a[68:71], v[192:207]
ds_read_b128 a[92:95], v39 offset:49152
ds_read_b128 a[96:99], v40 offset:49152
ds_read_b128 a[100:103], v41 offset:49152
s_waitcnt lgkmcnt(6)
v_mfma_f32_32x32x16_bf16 v[208:223], a[224:227], a[72:75], 0
s_lshl1_add_u32 s13, s95, 57344
buffer_load_dwordx4 v[122:125], v108, s[88:91], s13 offen sc1
buffer_load_dwordx4 v[126:129], v109, s[88:91], s13 offen sc1
v_mfma_f32_32x32x16_bf16 v[208:223], a[228:231], a[76:79], v[208:223]
v_cvt_pk_bf16_f32 v176, v192, v193
v_bitop3_b32 v176, s82, v106, v176 bitop3:202
v_cvt_pk_bf16_f32 v177, v194, v195
s_lshl_b32 s50, s94, 1
v_cvt_pk_bf16_f32 v178, v196, v197
s_waitcnt lgkmcnt(4)
v_mfma_f32_32x32x16_bf16 v[208:223], a[232:235], a[80:83], v[208:223]
v_cvt_pk_bf16_f32 v179, v198, v199
v_cvt_pk_bf16_f32 v180, v200, v201
v_bitop3_b32 v180, s82, v106, v180 bitop3:202
v_cvt_pk_bf16_f32 v181, v202, v203
v_cvt_pk_bf16_f32 v182, v204, v205
v_cvt_pk_bf16_f32 v183, v206, v207
v_mfma_f32_32x32x16_bf16 v[208:223], a[236:239], a[84:87], v[208:223]
s_barrier
buffer_store_dwordx4 v[176:179], v108, s[88:91], s50 offen
s_waitcnt lgkmcnt(2)
v_mfma_f32_32x32x16_bf16 v[208:223], a[240:243], a[88:91], v[208:223]
ds_read_b64_tr_b16 a[64:65], v46 offset:0
ds_read_b64_tr_b16 a[66:67], v46 offset:512
ds_read_b64_tr_b16 a[68:69], v46 offset:1024
ds_read_b64_tr_b16 a[70:71], v46 offset:1536
v_mfma_f32_32x32x16_bf16 v[208:223], a[244:247], a[92:95], v[208:223]
buffer_store_dwordx4 v[180:183], v109, s[88:91], s50 offen
s_waitcnt lgkmcnt(4)
v_mfma_f32_32x32x16_bf16 v[208:223], a[248:251], a[96:99], v[208:223]
ds_read_b64_tr_b16 a[72:73], v46 offset:4096
ds_read_b64_tr_b16 a[74:75], v46 offset:4608
ds_read_b64_tr_b16 a[76:77], v46 offset:5120
v_mfma_f32_32x32x16_bf16 v[208:223], a[252:255], a[100:103], v[208:223]
ds_read_b64_tr_b16 a[78:79], v46 offset:5632
ds_read_b64_tr_b16 a[80:81], v46 offset:8192
ds_read_b64_tr_b16 a[82:83], v46 offset:8704
s_waitcnt lgkmcnt(6)
v_mfma_f32_32x32x16_bf16 v[208:223], a[0:3], a[64:67], v[208:223]
buffer_load_dwordx4 v20, s[72:75], s100 offen offset:2048 lds
ds_read_b64_tr_b16 a[84:85], v46 offset:9216
ds_read_b64_tr_b16 a[86:87], v46 offset:9728
v_mfma_f32_32x32x16_bf16 v[208:223], a[4:7], a[68:71], v[208:223]
ds_read_b64_tr_b16 a[88:89], v46 offset:12288
ds_read_b64_tr_b16 a[90:91], v46 offset:12800
ds_read_b64_tr_b16 a[92:93], v46 offset:13312
s_waitcnt lgkmcnt(7)
v_mfma_f32_32x32x16_bf16 v[208:223], a[8:11], a[72:75], v[208:223]
buffer_load_dwordx4 v21, s[72:75], s100 offen offset:3072 lds
ds_read_b64_tr_b16 a[94:95], v46 offset:13824
v_mfma_f32_32x32x16_bf16 v[208:223], a[12:15], a[76:79], v[208:223]
s_barrier
ds_read_b64_tr_b16 a[96:97], v45 offset:0
s_waitcnt lgkmcnt(5)
v_mfma_f32_32x32x16_bf16 v[208:223], a[16:19], a[80:83], v[208:223]
ds_read_b64_tr_b16 a[98:99], v45 offset:512
s_add_u32 m0, s15, 32768
s_mul_i32 s100, s97, 448
buffer_load_dwordx4 v14, s[68:71], s100 offen offset:0 lds
v_mfma_f32_32x32x16_bf16 v[208:223], a[20:23], a[84:87], v[208:223]
ds_read_b64_tr_b16 a[100:101], v45 offset:1024
ds_read_b64_tr_b16 a[102:103], v45 offset:1536
ds_read_b64_tr_b16 a[64:65], v45 offset:4096
s_waitcnt lgkmcnt(5)
v_mfma_f32_32x32x16_bf16 v[208:223], a[24:27], a[88:91], v[208:223]
ds_read_b64_tr_b16 a[66:67], v45 offset:4608
buffer_load_dwordx4 v15, s[68:71], s100 offen offset:1024 lds
ds_read_b64_tr_b16 a[68:69], v45 offset:5120
v_mfma_f32_32x32x16_bf16 v[208:223], a[28:31], a[92:95], v[208:223]
ds_read_b64_tr_b16 a[70:71], v45 offset:5632
ds_read_b64_tr_b16 a[72:73], v45 offset:8192
ds_read_b64_tr_b16 a[74:75], v45 offset:8704
s_waitcnt lgkmcnt(6)
v_mfma_f32_32x32x16_bf16 v[208:223], a[32:35], a[96:99], v[208:223]
buffer_load_dwordx4 v16, s[68:71], s100 offen offset:2048 lds
ds_read_b64_tr_b16 a[76:77], v45 offset:9216
ds_read_b64_tr_b16 a[78:79], v45 offset:9728
v_mfma_f32_32x32x16_bf16 v[208:223], a[36:39], a[100:103], v[208:223]
buffer_load_dwordx4 v17, s[68:71], s100 offen offset:3072 lds
ds_read_b64_tr_b16 a[80:81], v45 offset:12288
s_waitcnt lgkmcnt(5)
v_mfma_f32_32x32x16_bf16 v[208:223], a[40:43], a[64:67], v[208:223]
ds_read_b64_tr_b16 a[82:83], v45 offset:12800
ds_read_b64_tr_b16 a[84:85], v45 offset:13312
ds_read_b64_tr_b16 a[86:87], v45 offset:13824
v_mfma_f32_32x32x16_bf16 v[208:223], a[44:47], a[68:71], v[208:223]
s_add_u32 m0, s15, 147456
s_mov_b32 s100, s97
buffer_load_dwordx4 v18, s[72:75], s100 offen offset:0 lds
s_waitcnt lgkmcnt(4)
v_mfma_f32_32x32x16_bf16 v[208:223], a[48:51], a[72:75], v[208:223]
s_waitcnt vmcnt(10)
v_bitop3_b32 v60, v105, v122, v123 bitop3:0xbd
v_bitop3_b32 v130, v105, v124, v125 bitop3:0xbd
s_waitcnt vmcnt(9)
v_bitop3_b32 v131, v105, v126, v127 bitop3:0xbd
v_bitop3_b32 v59, v105, v128, v129 bitop3:0xbd
v_mfma_f32_32x32x16_bf16 v[208:223], a[52:55], a[76:79], v[208:223]
s_barrier
v_or3_b32 v60, v60, v130, v131
v_bitop3_b32 v60, v60, v59, s82 bitop3:0xa8
v_cmp_ne_u32 vcc, 0, v60
s_cbranch_vccnz L_rp1
L_bp1:
v_mfma_f32_32x32x16_bf16 v[208:223], v[96:99], v[122:125], v[208:223]
buffer_load_dwordx4 v19, s[72:75], s100 offen offset:1024 lds
ds_read_b128 a[88:91], v30 offset:16384
ds_read_b128 a[92:95], v31 offset:16384
v_mfma_f32_32x32x16_bf16 v[208:223], v[100:103], v[126:129], v[208:223]
buffer_load_dwordx4 v20, s[72:75], s100 offen offset:2048 lds
ds_read_b128 a[96:99], v32 offset:16384
s_waitcnt lgkmcnt(3)
v_mfma_f32_32x32x16_bf16 v[208:223], a[56:59], a[80:83], v[208:223]
buffer_load_dwordx4 v21, s[72:75], s100 offen offset:3072 lds
ds_read_b128 a[100:103], v33 offset:16384
ds_read_b128 a[64:67], v34 offset:16384
v_mfma_f32_32x32x16_bf16 v[208:223], a[60:63], a[84:87], v[208:223]
ds_read_b128 a[68:71], v39 offset:16384
ds_read_b128 a[72:75], v40 offset:16384
ds_read_b128 a[76:79], v41 offset:16384
s_waitcnt lgkmcnt(6)
v_mfma_f32_32x32x16_bf16 v[192:207], a[224:227], a[88:91], 0
s_lshl_b32 s13, s96, 1
buffer_load_dwordx4 v[144:147], v108, s[88:91], s13 offen sc1
buffer_load_dwordx4 v[148:151], v109, s[88:91], s13 offen sc1
v_mfma_f32_32x32x16_bf16 v[192:207], a[228:231], a[92:95], v[192:207]
v_cvt_pk_bf16_f32 v176, v208, v209
v_cvt_pk_bf16_f32 v177, v210, v211
s_lshl1_add_u32 s50, s95, 57344
v_cvt_pk_bf16_f32 v178, v212, v213
v_bitop3_b32 v178, s82, v106, v178 bitop3:202
s_waitcnt lgkmcnt(4)
v_mfma_f32_32x32x16_bf16 v[192:207], a[232:235], a[96:99], v[192:207]
v_cvt_pk_bf16_f32 v179, v214, v215
v_cvt_pk_bf16_f32 v180, v216, v217
v_cvt_pk_bf16_f32 v181, v218, v219
v_cvt_pk_bf16_f32 v182, v220, v221
v_bitop3_b32 v182, s82, v106, v182 bitop3:202
v_cvt_pk_bf16_f32 v183, v222, v223
v_mfma_f32_32x32x16_bf16 v[192:207], a[236:239], a[100:103], v[192:207]
s_barrier
buffer_store_dwordx4 v[176:179], v108, s[88:91], s50 offen
s_waitcnt lgkmcnt(2)
v_mfma_f32_32x32x16_bf16 v[192:207], a[240:243], a[64:67], v[192:207]
ds_read_b64_tr_b16 a[80:81], v139 offset:0
ds_read_b64_tr_b16 a[82:83], v139 offset:512
ds_read_b64_tr_b16 a[84:85], v139 offset:1024
ds_read_b64_tr_b16 a[86:87], v139 offset:1536
v_mfma_f32_32x32x16_bf16 v[192:207], a[244:247], a[68:71], v[192:207]
buffer_store_dwordx4 v[180:183], v109, s[88:91], s50 offen
s_waitcnt lgkmcnt(4)
v_mfma_f32_32x32x16_bf16 v[192:207], a[248:251], a[72:75], v[192:207]
ds_read_b64_tr_b16 a[88:89], v139 offset:4096
ds_read_b64_tr_b16 a[90:91], v139 offset:4608
ds_read_b64_tr_b16 a[92:93], v139 offset:5120
s_movk_i32 s34, 0
v_mfma_f32_32x32x16_bf16 v[192:207], a[252:255], a[76:79], v[192:207]
ds_read_b64_tr_b16 a[94:95], v139 offset:5632
ds_read_b64_tr_b16 a[96:97], v139 offset:8192
ds_read_b64_tr_b16 a[98:99], v139 offset:8704
s_waitcnt lgkmcnt(6)
v_mfma_f32_32x32x16_bf16 v[192:207], a[0:3], a[80:83], v[192:207]
ds_read_b64_tr_b16 a[100:101], v139 offset:9216
ds_read_b64_tr_b16 a[102:103], v139 offset:9728
ds_read_b64_tr_b16 a[64:65], v139 offset:12288
s_movk_i32 s35, 3584
v_mfma_f32_32x32x16_bf16 v[192:207], a[4:7], a[84:87], v[192:207]
s_add_u32 m0, s15, 98304
s_add_u32 s100, s97, 114688
buffer_load_dwordx4 v18, s[72:75], s100 offen offset:0 lds
s_movk_i32 s36, 7168
s_waitcnt lgkmcnt(5)
v_mfma_f32_32x32x16_bf16 v[192:207], a[8:11], a[88:91], v[192:207]
ds_read_b64_tr_b16 a[66:67], v139 offset:12800
ds_read_b64_tr_b16 a[68:69], v139 offset:13312
ds_read_b64_tr_b16 a[70:71], v139 offset:13824
s_movk_i32 s37, 10752
v_mfma_f32_32x32x16_bf16 v[192:207], a[12:15], a[92:95], v[192:207]
s_waitcnt vmcnt(13)
s_barrier
buffer_load_dwordx4 v19, s[72:75], s100 offen offset:1024 lds
s_waitcnt lgkmcnt(4)
v_mfma_f32_32x32x16_bf16 v[192:207], a[16:19], a[96:99], v[192:207]
ds_read_b64_tr_b16 a[72:73], v139 offset:16384
ds_read_b64_tr_b16 a[74:75], v139 offset:16896
ds_read_b64_tr_b16 a[76:77], v139 offset:17408
s_movk_i32 s38, 14336
v_mfma_f32_32x32x16_bf16 v[192:207], a[20:23], a[100:103], v[192:207]
ds_read_b64_tr_b16 a[78:79], v139 offset:17920
buffer_load_dwordx4 v20, s[72:75], s100 offen offset:2048 lds
s_movk_i32 s39, 17920
s_waitcnt lgkmcnt(4)
v_mfma_f32_32x32x16_bf16 v[192:207], a[24:27], a[64:67], v[192:207]
ds_read_b64_tr_b16 a[80:81], v139 offset:20480
ds_read_b64_tr_b16 a[82:83], v139 offset:20992
buffer_load_dwordx4 v21, s[72:75], s100 offen offset:3072 lds
v_mfma_f32_32x32x16_bf16 v[192:207], a[28:31], a[68:71], v[192:207]
ds_read_b64_tr_b16 a[84:85], v139 offset:21504
ds_read_b64_tr_b16 a[86:87], v139 offset:22016
ds_read_b64_tr_b16 a[88:89], v139 offset:24576
s_waitcnt lgkmcnt(5)
v_mfma_f32_32x32x16_bf16 v[192:207], a[32:35], a[72:75], v[192:207]
ds_read_b64_tr_b16 a[90:91], v139 offset:25088
s_add_u32 m0, s15, 49152
s_mul_i32 s100, s98, 448
buffer_load_dwordx4 v14, s[68:71], s100 offen offset:0 lds
v_mfma_f32_32x32x16_bf16 v[192:207], a[36:39], a[76:79], v[192:207]
ds_read_b64_tr_b16 a[92:93], v139 offset:25600
ds_read_b64_tr_b16 a[94:95], v139 offset:26112
ds_read_b64_tr_b16 a[96:97], v139 offset:28672
s_waitcnt lgkmcnt(5)
v_mfma_f32_32x32x16_bf16 v[192:207], a[40:43], a[80:83], v[192:207]
buffer_load_dwordx4 v15, s[68:71], s100 offen offset:1024 lds
ds_read_b64_tr_b16 a[98:99], v139 offset:29184
ds_read_b64_tr_b16 a[100:101], v139 offset:29696
v_mfma_f32_32x32x16_bf16 v[192:207], a[44:47], a[84:87], v[192:207]
ds_read_b64_tr_b16 a[102:103], v139 offset:30208
s_movk_i32 s40, 21504
s_movk_i32 s41, 25088
s_waitcnt lgkmcnt(4)
v_mfma_f32_32x32x16_bf16 v[192:207], a[48:51], a[88:91], v[192:207]
s_waitcnt vmcnt(8)
v_bitop3_b32 v60, v106, v144, v148 bitop3:0x7e
v_and_b32 v60, s82, v60
buffer_load_dwordx4 v16, s[68:71], s100 offen offset:2048 lds
v_mfma_f32_32x32x16_bf16 v[192:207], a[52:55], a[92:95], v[192:207]
s_barrier
v_cmp_ne_u32 vcc, 0, v60
s_cbranch_vccnz L_rp2
L_bp2:
v_mfma_f32_32x32x16_bf16 v[192:207], v[96:99], v[144:147], v[192:207]
ds_read_b128 a[64:67], v140 offset:32768
buffer_load_dwordx4 v17, s[68:71], s100 offen offset:3072 lds
ds_read_b128 a[68:71], v23 offset:32768
v_mfma_f32_32x32x16_bf16 v[192:207], v[100:103], v[148:151], v[192:207]
s_add_u32 m0, s15, 114688
s_mov_b32 s100, s98
buffer_load_dwordx4 v18, s[72:75], s100 offen offset:0 lds
s_waitcnt lgkmcnt(2)
v_mfma_f32_32x32x16_bf16 v[192:207], a[56:59], a[96:99], v[192:207]
ds_read_b128 a[72:75], v24 offset:32768
ds_read_b128 a[76:79], v25 offset:32768
ds_read_b128 a[80:83], v26 offset:32768
v_mfma_f32_32x32x16_bf16 v[192:207], a[60:63], a[100:103], v[192:207]
ds_read_b128 a[84:87], v27 offset:32768
ds_read_b128 a[88:91], v28 offset:32768
ds_read_b128 a[92:95], v29 offset:32768
s_waitcnt lgkmcnt(6)
v_mfma_f32_32x32x16_bf16 v[208:223], a[224:227], a[64:67], 0
s_lshl1_add_u32 s13, s97, 57344
buffer_load_dwordx4 v[154:157], v108, s[88:91], s13 offen sc1
buffer_load_dwordx4 v[158:161], v109, s[88:91], s13 offen sc1
v_mfma_f32_32x32x16_bf16 v[208:223], a[228:231], a[68:71], v[208:223]
v_cvt_pk_bf16_f32 v176, v192, v193
v_bitop3_b32 v176, s82, v107, v176 bitop3:202
v_cvt_pk_bf16_f32 v177, v194, v195
s_lshl_b32 s50, s96, 1
v_cvt_pk_bf16_f32 v178, v196, v197
s_waitcnt lgkmcnt(4)
v_mfma_f32_32x32x16_bf16 v[208:223], a[232:235], a[72:75], v[208:223]
v_cvt_pk_bf16_f32 v179, v198, v199
v_cvt_pk_bf16_f32 v180, v200, v201
v_bitop3_b32 v180, s82, v107, v180 bitop3:202
v_cvt_pk_bf16_f32 v181, v202, v203
v_cvt_pk_bf16_f32 v182, v204, v205
v_cvt_pk_bf16_f32 v183, v206, v207
v_mfma_f32_32x32x16_bf16 v[208:223], a[236:239], a[76:79], v[208:223]
s_barrier
buffer_store_dwordx4 v[176:179], v108, s[88:91], s50 offen
s_waitcnt lgkmcnt(2)
v_mfma_f32_32x32x16_bf16 v[208:223], a[240:243], a[80:83], v[208:223]
ds_read_b64_tr_b16 a[96:97], v46 offset:16384
ds_read_b64_tr_b16 a[98:99], v46 offset:16896
ds_read_b64_tr_b16 a[100:101], v46 offset:17408
ds_read_b64_tr_b16 a[102:103], v46 offset:17920
v_mfma_f32_32x32x16_bf16 v[208:223], a[244:247], a[84:87], v[208:223]
buffer_store_dwordx4 v[180:183], v109, s[88:91], s50 offen
s_waitcnt lgkmcnt(4)
v_mfma_f32_32x32x16_bf16 v[208:223], a[248:251], a[88:91], v[208:223]
ds_read_b64_tr_b16 a[64:65], v46 offset:20480
ds_read_b64_tr_b16 a[66:67], v46 offset:20992
ds_read_b64_tr_b16 a[68:69], v46 offset:21504
v_mfma_f32_32x32x16_bf16 v[208:223], a[252:255], a[92:95], v[208:223]
ds_read_b64_tr_b16 a[70:71], v46 offset:22016
ds_read_b64_tr_b16 a[72:73], v46 offset:24576
ds_read_b64_tr_b16 a[74:75], v46 offset:25088
s_waitcnt lgkmcnt(6)
v_mfma_f32_32x32x16_bf16 v[208:223], a[0:3], a[96:99], v[208:223]
buffer_load_dwordx4 v19, s[72:75], s100 offen offset:1024 lds
ds_read_b64_tr_b16 a[76:77], v46 offset:25600
ds_read_b64_tr_b16 a[78:79], v46 offset:26112
v_mfma_f32_32x32x16_bf16 v[208:223], a[4:7], a[100:103], v[208:223]
ds_read_b64_tr_b16 a[80:81], v46 offset:28672
ds_read_b64_tr_b16 a[82:83], v46 offset:29184
ds_read_b64_tr_b16 a[84:85], v46 offset:29696
s_waitcnt lgkmcnt(7)
v_mfma_f32_32x32x16_bf16 v[208:223], a[8:11], a[64:67], v[208:223]
buffer_load_dwordx4 v20, s[72:75], s100 offen offset:2048 lds
ds_read_b64_tr_b16 a[86:87], v46 offset:30208
v_mfma_f32_32x32x16_bf16 v[208:223], a[12:15], a[68:71], v[208:223]
s_waitcnt vmcnt(11)
s_barrier
ds_read_b64_tr_b16 a[88:89], v45 offset:32768
s_waitcnt lgkmcnt(5)
v_mfma_f32_32x32x16_bf16 v[208:223], a[16:19], a[72:75], v[208:223]
ds_read_b64_tr_b16 a[90:91], v45 offset:33280
buffer_load_dwordx4 v21, s[72:75], s100 offen offset:3072 lds
ds_read_b64_tr_b16 a[92:93], v45 offset:33792
v_mfma_f32_32x32x16_bf16 v[208:223], a[20:23], a[76:79], v[208:223]
ds_read_b64_tr_b16 a[94:95], v45 offset:34304
ds_read_b64_tr_b16 a[96:97], v45 offset:36864
ds_read_b64_tr_b16 a[98:99], v45 offset:37376
s_waitcnt lgkmcnt(6)
v_mfma_f32_32x32x16_bf16 v[208:223], a[24:27], a[80:83], v[208:223]
s_add_u32 m0, s15, 131072
s_add_u32 s100, s98, 114688
buffer_load_dwordx4 v18, s[72:75], s100 offen offset:0 lds
ds_read_b64_tr_b16 a[100:101], v45 offset:37888
v_mfma_f32_32x32x16_bf16 v[208:223], a[28:31], a[84:87], v[208:223]
ds_read_b64_tr_b16 a[102:103], v45 offset:38400
ds_read_b64_tr_b16 a[64:65], v45 offset:40960
ds_read_b64_tr_b16 a[66:67], v45 offset:41472
s_waitcnt lgkmcnt(6)
v_mfma_f32_32x32x16_bf16 v[208:223], a[32:35], a[88:91], v[208:223]
buffer_load_dwordx4 v19, s[72:75], s100 offen offset:1024 lds
ds_read_b64_tr_b16 a[68:69], v45 offset:41984
ds_read_b64_tr_b16 a[70:71], v45 offset:42496
v_mfma_f32_32x32x16_bf16 v[208:223], a[36:39], a[92:95], v[208:223]
buffer_load_dwordx4 v20, s[72:75], s100 offen offset:2048 lds
ds_read_b64_tr_b16 a[72:73], v45 offset:45056
s_waitcnt lgkmcnt(5)
v_mfma_f32_32x32x16_bf16 v[208:223], a[40:43], a[96:99], v[208:223]
ds_read_b64_tr_b16 a[74:75], v45 offset:45568
ds_read_b64_tr_b16 a[76:77], v45 offset:46080
ds_read_b64_tr_b16 a[78:79], v45 offset:46592
v_mfma_f32_32x32x16_bf16 v[208:223], a[44:47], a[100:103], v[208:223]
buffer_load_dwordx4 v21, s[72:75], s100 offen offset:3072 lds
s_waitcnt lgkmcnt(4)
v_mfma_f32_32x32x16_bf16 v[208:223], a[48:51], a[64:67], v[208:223]
s_waitcnt vmcnt(9)
v_bitop3_b32 v60, v106, v156, v160 bitop3:0x7e
v_and_b32 v60, s82, v60
v_mfma_f32_32x32x16_bf16 v[208:223], a[52:55], a[68:71], v[208:223]
s_barrier
v_cmp_ne_u32 vcc, 0, v60
s_cbranch_vccnz L_rp3
L_bp3:
v_mfma_f32_32x32x16_bf16 v[208:223], v[96:99], v[154:157], v[208:223]
ds_read_b128 a[80:83], v140 offset:49152
ds_read_b128 a[84:87], v23 offset:49152
ds_read_b128 a[88:91], v24 offset:49152
v_mfma_f32_32x32x16_bf16 v[208:223], v[100:103], v[158:161], v[208:223]
ds_read_b128 a[92:95], v25 offset:49152
ds_read_b128 a[96:99], v26 offset:49152
ds_read_b128 a[100:103], v27 offset:49152
s_waitcnt lgkmcnt(6)
v_mfma_f32_32x32x16_bf16 v[208:223], a[56:59], a[72:75], v[208:223]
ds_read_b128 a[64:67], v28 offset:49152
ds_read_b128 a[68:71], v29 offset:49152
v_mfma_f32_32x32x16_bf16 v[208:223], a[60:63], a[76:79], v[208:223]
s_waitcnt lgkmcnt(6)
v_mfma_f32_32x32x16_bf16 v[64:79], a[224:227], a[80:83], v[64:79]
s_lshl_b32 s13, s98, 1
buffer_load_dwordx4 v[164:167], v108, s[88:91], s13 offen sc1
buffer_load_dwordx4 v[168:171], v109, s[88:91], s13 offen sc1
v_mfma_f32_32x32x16_bf16 v[64:79], a[228:231], a[84:87], v[64:79]
v_cvt_pk_bf16_f32 v176, v208, v209
v_cvt_pk_bf16_f32 v177, v210, v211
s_lshl1_add_u32 s50, s97, 57344
v_cvt_pk_bf16_f32 v178, v212, v213
v_bitop3_b32 v178, s82, v107, v178 bitop3:202
s_waitcnt lgkmcnt(4)
v_mfma_f32_32x32x16_bf16 v[64:79], a[232:235], a[88:91], v[64:79]
v_cvt_pk_bf16_f32 v179, v214, v215
v_cvt_pk_bf16_f32 v180, v216, v217
v_cvt_pk_bf16_f32 v181, v218, v219
v_cvt_pk_bf16_f32 v182, v220, v221
v_bitop3_b32 v182, s82, v107, v182 bitop3:202
v_cvt_pk_bf16_f32 v183, v222, v223
v_mfma_f32_32x32x16_bf16 v[64:79], a[236:239], a[92:95], v[64:79]
s_waitcnt vmcnt(6)
s_barrier
buffer_store_dwordx4 v[176:179], v108, s[88:91], s50 offen
s_waitcnt lgkmcnt(2)
v_mfma_f32_32x32x16_bf16 v[64:79], a[240:243], a[96:99], v[64:79]
ds_read_b64_tr_b16 a[72:73], v45 offset:49152
ds_read_b64_tr_b16 a[74:75], v45 offset:49664
ds_read_b64_tr_b16 a[76:77], v45 offset:50176
ds_read_b64_tr_b16 a[78:79], v45 offset:50688
v_mfma_f32_32x32x16_bf16 v[64:79], a[244:247], a[100:103], v[64:79]
buffer_store_dwordx4 v[180:183], v109, s[88:91], s50 offen
s_waitcnt lgkmcnt(4)
v_mfma_f32_32x32x16_bf16 v[64:79], a[248:251], a[64:67], v[64:79]
ds_read_b64_tr_b16 a[80:81], v45 offset:53248
ds_read_b64_tr_b16 a[82:83], v45 offset:53760
ds_read_b64_tr_b16 a[84:85], v45 offset:54272
v_mfma_f32_32x32x16_bf16 v[64:79], a[252:255], a[68:71], v[64:79]
ds_read_b64_tr_b16 a[86:87], v45 offset:54784
ds_read_b64_tr_b16 a[88:89], v45 offset:57344
ds_read_b64_tr_b16 a[90:91], v45 offset:57856
s_waitcnt lgkmcnt(6)
v_mfma_f32_32x32x16_bf16 v[64:79], a[0:3], a[72:75], v[64:79]
ds_read_b64_tr_b16 a[92:93], v45 offset:58368
ds_read_b64_tr_b16 a[94:95], v45 offset:58880
ds_read_b64_tr_b16 a[96:97], v45 offset:61440
v_mfma_f32_32x32x16_bf16 v[64:79], a[4:7], a[76:79], v[64:79]
ds_read_b64_tr_b16 a[98:99], v45 offset:61952
ds_read_b64_tr_b16 a[100:101], v45 offset:62464
ds_read_b64_tr_b16 a[102:103], v45 offset:62976
s_waitcnt lgkmcnt(8)
v_mfma_f32_32x32x16_bf16 v[64:79], a[8:11], a[80:83], v[64:79]
v_mfma_f32_32x32x16_bf16 v[64:79], a[12:15], a[84:87], v[64:79]
s_waitcnt vmcnt(4)
s_barrier
ds_read_b64_tr_b16 a[64:65], v46 offset:0
s_waitcnt lgkmcnt(5)
v_mfma_f32_32x32x16_bf16 v[64:79], a[16:19], a[88:91], v[64:79]
ds_read_b64_tr_b16 a[66:67], v46 offset:512
ds_read_b64_tr_b16 a[68:69], v46 offset:1024
ds_read_b64_tr_b16 a[70:71], v46 offset:1536
v_mfma_f32_32x32x16_bf16 v[64:79], a[20:23], a[92:95], v[64:79]
ds_read_b64_tr_b16 a[72:73], v46 offset:4096
ds_read_b64_tr_b16 a[74:75], v46 offset:4608
ds_read_b64_tr_b16 a[76:77], v46 offset:5120
s_waitcnt lgkmcnt(7)
v_mfma_f32_32x32x16_bf16 v[64:79], a[24:27], a[96:99], v[64:79]
ds_read_b64_tr_b16 a[78:79], v46 offset:5632
ds_read_b64_tr_b16 a[80:81], v46 offset:8192
ds_read_b64_tr_b16 a[82:83], v46 offset:8704
v_mfma_f32_32x32x16_bf16 v[64:79], a[28:31], a[100:103], v[64:79]
ds_read_b64_tr_b16 a[84:85], v46 offset:9216
ds_read_b64_tr_b16 a[86:87], v46 offset:9728
ds_read_b64_tr_b16 a[88:89], v46 offset:12288
s_waitcnt lgkmcnt(9)
v_mfma_f32_32x32x16_bf16 v[64:79], a[32:35], a[64:67], v[64:79]
s_lshl1_add_u32 s13, s98, 57344
buffer_load_dwordx4 v[224:227], v108, s[88:91], s13 offen sc1
buffer_load_dwordx4 v[228:231], v109, s[88:91], s13 offen sc1
v_mfma_f32_32x32x16_bf16 v[64:79], a[36:39], a[68:71], v[64:79]
ds_read_b64_tr_b16 a[90:91], v46 offset:12800
ds_read_b64_tr_b16 a[92:93], v46 offset:13312
ds_read_b64_tr_b16 a[94:95], v46 offset:13824
s_waitcnt lgkmcnt(8)
v_mfma_f32_32x32x16_bf16 v[64:79], a[40:43], a[72:75], v[64:79]
v_mfma_f32_32x32x16_bf16 v[64:79], a[44:47], a[76:79], v[64:79]
s_waitcnt lgkmcnt(4)
v_mfma_f32_32x32x16_bf16 v[64:79], a[48:51], a[80:83], v[64:79]
s_waitcnt vmcnt(4)
v_bitop3_b32 v60, v107, v164, v168 bitop3:0x7e
v_and_b32 v60, s82, v60
v_mfma_f32_32x32x16_bf16 v[64:79], a[52:55], a[84:87], v[64:79]
v_cmp_ne_u32 vcc, 0, v60
s_cbranch_vccnz L_rp4
L_bp4:
v_mfma_f32_32x32x16_bf16 v[64:79], v[96:99], v[164:167], v[64:79]
v_mfma_f32_32x32x16_bf16 v[64:79], v[100:103], v[168:171], v[64:79]
s_waitcnt lgkmcnt(0)
v_mfma_f32_32x32x16_bf16 v[64:79], a[56:59], a[88:91], v[64:79]
v_mfma_f32_32x32x16_bf16 v[64:79], a[60:63], a[92:95], v[64:79]
s_waitcnt vmcnt(0)
v_bitop3_b32 v60, v107, v226, v230 bitop3:0x7e
v_and_b32 v60, s82, v60
v_cmp_ne_u32 vcc, 0, v60
s_cbranch_vccnz L_rp5
L_bp5:
v_mfma_f32_32x32x16_bf16 v[64:79], v[96:99], v[224:227], v[64:79]
v_mfma_f32_32x32x16_bf16 v[64:79], v[100:103], v[228:231], v[64:79]
s_nop 11
v_pk_mul_f32 v[64:65], v[64:65], v[80:81]
v_pk_mul_f32 v[66:67], v[66:67], v[82:83]
v_pk_mul_f32 v[68:69], v[68:69], v[84:85]
v_pk_mul_f32 v[70:71], v[70:71], v[86:87]
v_pk_mul_f32 v[72:73], v[72:73], v[88:89]
v_pk_mul_f32 v[74:75], v[74:75], v[90:91]
v_pk_mul_f32 v[76:77], v[76:77], v[92:93]
v_pk_mul_f32 v[78:79], v[78:79], v[94:95]
buffer_store_dword v64, v110, s[88:91], s34 offen offset:0
buffer_store_dword v65, v110, s[88:91], s34 offen offset:1792
buffer_store_dword v66, v110, s[88:91], s35 offen offset:0
buffer_store_dword v67, v110, s[88:91], s35 offen offset:1792
buffer_store_dword v68, v110, s[88:91], s36 offen offset:0
buffer_store_dword v69, v110, s[88:91], s36 offen offset:1792
buffer_store_dword v70, v110, s[88:91], s37 offen offset:0
buffer_store_dword v71, v110, s[88:91], s37 offen offset:1792
buffer_store_dword v72, v110, s[88:91], s38 offen offset:0
buffer_store_dword v73, v110, s[88:91], s38 offen offset:1792
buffer_store_dword v74, v110, s[88:91], s39 offen offset:0
buffer_store_dword v75, v110, s[88:91], s39 offen offset:1792
buffer_store_dword v76, v110, s[88:91], s40 offen offset:0
buffer_store_dword v77, v110, s[88:91], s40 offen offset:1792
buffer_store_dword v78, v110, s[88:91], s41 offen offset:0
buffer_store_dword v79, v110, s[88:91], s41 offen offset:1792
s_lshl_b32 s50, s12, 2
s_add_u32 s50, s50, s3
s_lshl_b32 s50, s50, 5
s_add_u32 s50, s50, s11
s_cmp_lg_u32 s50, 31
s_cbranch_scc1 L_exit
v_mov_b32 v0, 0
global_store_dword v0, v104, s[48:49] sc1
L_exit:
s_endpgm
L_rp0:
s_lshl_b32 s51, s94, 1
buffer_load_dwordx4 v[112:115], v108, s[88:91], s51 offen sc1
buffer_load_dwordx4 v[116:119], v109, s[88:91], s51 offen sc1
s_add_u32 s99, s99, 1
s_waitcnt vmcnt(0)
s_cmp_gt_u32 s99, 0x8000
s_cbranch_scc1 L_bp0
v_bitop3_b32 v60, v105, v112, v113 bitop3:0xbd
v_bitop3_b32 v120, v105, v114, v115 bitop3:0xbd
v_bitop3_b32 v121, v105, v116, v117 bitop3:0xbd
v_bitop3_b32 v59, v105, v118, v119 bitop3:0xbd
v_or3_b32 v60, v60, v120, v121
v_bitop3_b32 v60, v60, v59, s82 bitop3:0xa8
v_cmp_ne_u32 vcc, 0, v60
s_cbranch_vccnz L_rp0
s_branch L_bp0
L_rp1:
s_lshl1_add_u32 s51, s95, 57344
buffer_load_dwordx4 v[122:125], v108, s[88:91], s51 offen sc1
buffer_load_dwordx4 v[126:129], v109, s[88:91], s51 offen sc1
s_add_u32 s99, s99, 1
s_waitcnt vmcnt(0)
s_cmp_gt_u32 s99, 0x8000
s_cbranch_scc1 L_bp1
v_bitop3_b32 v60, v105, v122, v123 bitop3:0xbd
v_bitop3_b32 v130, v105, v124, v125 bitop3:0xbd
v_bitop3_b32 v131, v105, v126, v127 bitop3:0xbd
v_bitop3_b32 v59, v105, v128, v129 bitop3:0xbd
v_or3_b32 v60, v60, v130, v131
v_bitop3_b32 v60, v60, v59, s82 bitop3:0xa8
v_cmp_ne_u32 vcc, 0, v60
s_cbranch_vccnz L_rp1
s_branch L_bp1
L_rp2:
s_lshl_b32 s51, s96, 1
buffer_load_dwordx4 v[144:147], v108, s[88:91], s51 offen sc1
buffer_load_dwordx4 v[148:151], v109, s[88:91], s51 offen sc1
s_add_u32 s99, s99, 1
s_waitcnt vmcnt(0)
s_cmp_gt_u32 s99, 0x8000
s_cbranch_scc1 L_bp2
v_bitop3_b32 v60, v106, v144, v148 bitop3:0x7e
v_and_b32 v60, s82, v60
v_cmp_ne_u32 vcc, 0, v60
s_cbranch_vccnz L_rp2
s_branch L_bp2
L_rp3:
s_lshl1_add_u32 s51, s97, 57344
buffer_load_dwordx4 v[154:157], v108, s[88:91], s51 offen sc1
buffer_load_dwordx4 v[158:161], v109, s[88:91], s51 offen sc1
s_add_u32 s99, s99, 1
s_waitcnt vmcnt(0)
s_cmp_gt_u32 s99, 0x8000
s_cbranch_scc1 L_bp3
v_bitop3_b32 v60, v106, v156, v160 bitop3:0x7e
v_and_b32 v60, s82, v60
v_cmp_ne_u32 vcc, 0, v60
s_cbranch_vccnz L_rp3
s_branch L_bp3
L_rp4:
s_lshl_b32 s51, s98, 1
buffer_load_dwordx4 v[164:167], v108, s[88:91], s51 offen sc1
buffer_load_dwordx4 v[168:171], v109, s[88:91], s51 offen sc1
s_add_u32 s99, s99, 1
s_waitcnt vmcnt(0)
s_cmp_gt_u32 s99, 0x8000
s_cbranch_scc1 L_bp4
v_bitop3_b32 v60, v107, v164, v168 bitop3:0x7e
v_and_b32 v60, s82, v60
v_cmp_ne_u32 vcc, 0, v60
s_cbranch_vccnz L_rp4
s_branch L_bp4
L_rp5:
s_lshl1_add_u32 s51, s98, 57344
buffer_load_dwordx4 v[224:227], v108, s[88:91], s51 offen sc1
buffer_load_dwordx4 v[228:231], v109, s[88:91], s51 offen sc1
s_add_u32 s99, s99, 1
s_waitcnt vmcnt(0)
s_cmp_gt_u32 s99, 0x8000
s_cbranch_scc1 L_bp5
v_bitop3_b32 v60, v107, v226, v230 bitop3:0x7e
v_and_b32 v60, s82, v60
v_cmp_ne_u32 vcc, 0, v60
s_cbranch_vccnz L_rp5
s_branch L_bp5
L_eretry:
s_mov_b32 s80, m0
s_add_u32 m0, s15, 114688
L_eloop:
s_add_u32 s99, s99, 1
buffer_load_dwordx4 v57, s[76:79], 0 offen offset:0 sc1 lds
buffer_load_dwordx4 v57, s[76:79], 0 offen offset:1024 sc1 lds
buffer_load_dwordx4 v57, s[76:79], 0 offen offset:2048 sc1 lds
buffer_load_dwordx4 v57, s[76:79], 0 offen offset:3072 sc1 lds
s_waitcnt vmcnt(0)
ds_read2st64_b32 v[126:127], v129 offset0:3 offset1:7
ds_read2st64_b32 v[124:125], v141 offset0:3 offset1:7
ds_read2st64_b32 v[122:123], v129 offset0:2 offset1:6
ds_read2st64_b32 v[120:121], v141 offset0:2 offset1:6
ds_read2st64_b32 v[118:119], v129 offset0:1 offset1:5
ds_read2st64_b32 v[116:117], v141 offset0:1 offset1:5
ds_read2st64_b32 v[114:115], v129 offset0:0 offset1:4
ds_read2st64_b32 v[112:113], v141 offset0:0 offset1:4
s_cmp_gt_u32 s99, 0x8000
s_waitcnt lgkmcnt(0)
s_cbranch_scc1 L_edone
v_add_u32_sdwa v130, v126, v127 dst_sel:DWORD dst_unused:UNUSED_PAD src0_sel:BYTE_0 src1_sel:BYTE_0
v_add_u32_sdwa v131, v124, v125 dst_sel:DWORD dst_unused:UNUSED_PAD src0_sel:BYTE_0 src1_sel:BYTE_0
v_add3_u32 v8, v130, v131, 0
v_add_u32_sdwa v130, v122, v123 dst_sel:DWORD dst_unused:UNUSED_PAD src0_sel:BYTE_0 src1_sel:BYTE_0
v_add_u32_sdwa v131, v120, v121 dst_sel:DWORD dst_unused:UNUSED_PAD src0_sel:BYTE_0 src1_sel:BYTE_0
v_add3_u32 v8, v130, v131, v8
v_add_u32_sdwa v130, v118, v119 dst_sel:DWORD dst_unused:UNUSED_PAD src0_sel:BYTE_0 src1_sel:BYTE_0
v_add_u32_sdwa v131, v116, v117 dst_sel:DWORD dst_unused:UNUSED_PAD src0_sel:BYTE_0 src1_sel:BYTE_0
v_add3_u32 v8, v130, v131, v8
v_add_u32_sdwa v130, v114, v115 dst_sel:DWORD dst_unused:UNUSED_PAD src0_sel:BYTE_0 src1_sel:BYTE_0
v_add_u32_sdwa v131, v112, v113 dst_sel:DWORD dst_unused:UNUSED_PAD src0_sel:BYTE_0 src1_sel:BYTE_0
v_add3_u32 v8, v130, v131, v8
v_cmp_ne_u32 vcc, v8, v9
s_cbranch_vccnz L_eloop
L_edone:
s_mov_b32 m0, s80
s_branch L_eback
L_mode:
v_min_u32 v42, 6, v1
v_lshlrev_b32 v42, 2, v42
buffer_load_dword v42, v42, s[84:87], 0 offen offset:0 sc1
s_add_u32 s99, s99, 1
s_waitcnt vmcnt(0)
s_cmp_gt_u32 s99, 0x8000
s_cbranch_scc1 L_nearF
v_subrev_u32 v60, s14, v42
v_cmp_lt_u32 vcc, 15, v60
s_cbranch_vccnz L_mode
v_cmp_ne_u32 vcc, s83, v42
s_cbranch_vccnz L_nearF
s_branch L_near
L_pf:
v_lshlrev_b32 v7, 7, v0
s_and_b32 s50, 7, s2
s_lshr_b32 s51, s2, 3
s_lshl2_add_u32 s50, s50, s51
s_mov_b32 s79, 0x20000
s_waitcnt lgkmcnt(0)
s_waitcnt vmcnt(0)
s_and_b32 s80, s2, 7
s_add_u32 s80, s80, 2
s_cmp_ge_u32 s80, 7
s_cselect_b32 s81, 7, 0
s_sub_u32 s80, s80, s81
v_min_u32 v1, 149, v0
v_add_u32 v1, 0, v1
v_lshrrev_b32 v2, 6, v1
v_add_u32 v3, s80, v2
v_subrev_u32 v4, 7, v3
v_min_u32 v3, v3, v4
s_add_u32 s76, s36, 0
s_addc_u32 s77, s37, 0
s_mov_b32 s78, 1605632
v_bfe_u32 v4, v1, 2, 4
v_lshl_add_u32 v4, v3, 6, v4
v_lshl_add_u32 v4, s51, 4, v4
v_mul_u32_u24 v4, 3584, v4
v_and_b32 v1, 3, v1
v_lshl_add_u32 v1, v2, 2, v1
v_lshl_add_u32 v4, v1, 7, v4
buffer_load_dword v8, v4, s[76:79], 0 offen
s_waitcnt vmcnt(0)
s_and_b32 s80, s2, 7
s_add_u32 s80, s80, 2
s_cmp_ge_u32 s80, 7
s_cselect_b32 s81, 7, 0
s_sub_u32 s80, s80, s81
v_min_u32 v1, 149, v0
v_add_u32 v1, 150, v1
v_lshrrev_b32 v2, 6, v1
v_add_u32 v3, s80, v2
v_subrev_u32 v4, 7, v3
v_min_u32 v3, v3, v4
s_add_u32 s76, s36, 0
s_addc_u32 s77, s37, 0
s_mov_b32 s78, 1605632
v_bfe_u32 v4, v1, 2, 4
v_lshl_add_u32 v4, v3, 6, v4
v_lshl_add_u32 v4, s51, 4, v4
v_mul_u32_u24 v4, 3584, v4
v_and_b32 v1, 3, v1
v_lshl_add_u32 v1, v2, 2, v1
v_lshl_add_u32 v4, v1, 7, v4
buffer_load_dword v9, v4, s[76:79], 0 offen
s_waitcnt vmcnt(0)
s_and_b32 s80, s2, 7
s_add_u32 s80, s80, 2
s_cmp_ge_u32 s80, 7
s_cselect_b32 s81, 7, 0
s_sub_u32 s80, s80, s81
v_min_u32 v1, 147, v0
v_add_u32 v1, 300, v1
v_lshrrev_b32 v2, 6, v1
v_add_u32 v3, s80, v2
v_subrev_u32 v4, 7, v3
v_min_u32 v3, v3, v4
s_add_u32 s76, s36, 0
s_addc_u32 s77, s37, 0
s_mov_b32 s78, 1605632
v_bfe_u32 v4, v1, 2, 4
v_lshl_add_u32 v4, v3, 6, v4
v_lshl_add_u32 v4, s51, 4, v4
v_mul_u32_u24 v4, 3584, v4
v_and_b32 v1, 3, v1
v_lshl_add_u32 v1, v2, 2, v1
v_lshl_add_u32 v4, v1, 7, v4
buffer_load_dword v10, v4, s[76:79], 0 offen
s_waitcnt vmcnt(0)
s_and_b32 s80, s2, 7
s_add_u32 s81, s80, 3
s_cmp_ge_u32 s81, 6
s_cselect_b32 s82, 5, -1
s_sub_u32 s81, s81, s82
s_cmp_ge_u32 s80, 6
s_cselect_b32 s80, 0, s81
v_min_u32 v1, 111, v0
v_add_u32 v1, 0, v1
v_lshrrev_b32 v2, 4, v1
v_add_u32 v3, s80, v2
v_subrev_u32 v4, 7, v3
v_min_u32 v3, v3, v4
s_add_u32 s76, s26, 0
s_addc_u32 s77, s27, 0
s_mov_b32 s78, 401408
v_and_b32 v4, 15, v1
v_lshl_add_u32 v4, v3, 6, v4
v_lshl_add_u32 v4, s51, 4, v4
v_mul_u32_u24 v4, 896, v4
v_lshl_add_u32 v4, v2, 7, v4
buffer_load_dword v11, v4, s[76:79], 0 offen
s_and_b32 s80, s2, 7
s_add_u32 s81, s80, 3
s_cmp_ge_u32 s81, 6
s_cselect_b32 s82, 5, -1
s_sub_u32 s81, s81, s82
s_cmp_ge_u32 s80, 6
s_cselect_b32 s80, 0, s81
v_min_u32 v1, 111, v0
v_add_u32 v1, 0, v1
v_lshrrev_b32 v2, 4, v1
v_add_u32 v3, s80, v2
v_subrev_u32 v4, 7, v3
v_min_u32 v3, v3, v4
s_add_u32 s76, s28, 0
s_addc_u32 s77, s29, 0
s_mov_b32 s78, 401408
v_and_b32 v4, 15, v1
v_lshl_add_u32 v4, v3, 6, v4
v_lshl_add_u32 v4, s51, 4, v4
v_mul_u32_u24 v4, 896, v4
v_lshl_add_u32 v4, v2, 7, v4
buffer_load_dword v12, v4, s[76:79], 0 offen
s_waitcnt vmcnt(0)
s_and_b32 s80, s2, 7
s_add_u32 s81, s80, 3
s_cmp_ge_u32 s81, 6
s_cselect_b32 s82, 5, -1
s_sub_u32 s81, s81, s82
s_cmp_ge_u32 s80, 6
s_cselect_b32 s80, 0, s81
v_min_u32 v1, 223, v0
v_add_u32 v1, 0, v1
v_lshrrev_b32 v2, 6, v1
v_add_u32 v3, s80, v2
v_subrev_u32 v4, 7, v3
v_min_u32 v3, v3, v4
s_add_u32 s76, s40, 0
s_addc_u32 s77, s41, 0
s_mov_b32 s78, 1605632
v_and_b32 v4, 63, v1
v_lshl_add_u32 v4, v2, 8, v4
v_lshl_add_u32 v4, s51, 6, v4
v_mul_u32_u24 v4, 896, v4
v_lshl_add_u32 v4, v3, 7, v4
buffer_load_dword v13, v4, s[76:79], 0 offen
s_waitcnt vmcnt(0)
s_and_b32 s80, s2, 7
s_add_u32 s81, s80, 3
s_cmp_ge_u32 s81, 6
s_cselect_b32 s82, 5, -1
s_sub_u32 s81, s81, s82
s_cmp_ge_u32 s80, 6
s_cselect_b32 s80, 0, s81
v_min_u32 v1, 223, v0
v_add_u32 v1, 224, v1
v_lshrrev_b32 v2, 6, v1
v_add_u32 v3, s80, v2
v_subrev_u32 v4, 7, v3
v_min_u32 v3, v3, v4
s_add_u32 s76, s40, 0
s_addc_u32 s77, s41, 0
s_mov_b32 s78, 1605632
v_and_b32 v4, 63, v1
v_lshl_add_u32 v4, v2, 8, v4
v_lshl_add_u32 v4, s51, 6, v4
v_mul_u32_u24 v4, 896, v4
v_lshl_add_u32 v4, v3, 7, v4
buffer_load_dword v14, v4, s[76:79], 0 offen
s_waitcnt vmcnt(0)
s_mul_i32 s76, s50, 114688
s_add_u32 s76, s76, 0
s_add_u32 s76, s76, s44
s_addc_u32 s77, s45, 0
s_mov_b32 s78, 28672
buffer_load_dword v15, v7, s[76:79], 0 offen
s_waitcnt vmcnt(0)
s_mul_i32 s76, s50, 114688
s_add_u32 s76, s76, 28672
s_add_u32 s76, s76, s44
s_addc_u32 s77, s45, 0
s_mov_b32 s78, 28672
buffer_load_dword v16, v7, s[76:79], 0 offen
s_waitcnt vmcnt(0)
s_mul_i32 s76, s50, 114688
s_add_u32 s76, s76, 57344
s_add_u32 s76, s76, s44
s_addc_u32 s77, s45, 0
s_mov_b32 s78, 28672
buffer_load_dword v17, v7, s[76:79], 0 offen
s_waitcnt vmcnt(0)
s_mul_i32 s76, s50, 114688
s_add_u32 s76, s76, 86016
s_add_u32 s76, s76, s44
s_addc_u32 s77, s45, 0
s_mov_b32 s78, 28672
buffer_load_dword v18, v7, s[76:79], 0 offen
L_pe:
s_endpgm
L_nearF:
v_mfma_f32_32x32x16_bf16 v[192:207], a[44:47], a[100:103], v[192:207]
s_waitcnt lgkmcnt(4) vmcnt(20)
s_barrier
ds_read_b64_tr_b16 a[76:77], v45 offset:29696
ds_read_b64_tr_b16 a[78:79], v45 offset:30208
s_waitcnt lgkmcnt(4)
v_mfma_f32_32x32x16_bf16 v[192:207], a[48:51], a[64:67], v[192:207]
s_add_u32 m0, s15, 114688
s_mul_i32 s100, s95, 448
buffer_load_dwordx4 v14, s[68:71], s100 offen offset:0 lds
ds_read_b128 a[80:83], v140 offset:0
v_mfma_f32_32x32x16_bf16 v[192:207], a[52:55], a[68:71], v[192:207]
buffer_load_dwordx4 v15, s[68:71], s100 offen offset:1024 lds
ds_read_b128 a[84:87], v23 offset:0
s_waitcnt lgkmcnt(2)
v_mfma_f32_32x32x16_bf16 v[192:207], a[56:59], a[72:75], v[192:207]
ds_read_b128 a[88:91], v24 offset:0
buffer_load_dwordx4 v16, s[68:71], s100 offen offset:2048 lds
ds_read_b128 a[92:95], v25 offset:0
v_mfma_f32_32x32x16_bf16 v[192:207], a[60:63], a[76:79], v[192:207]
ds_read_b128 a[96:99], v26 offset:0
ds_read_b128 a[100:103], v27 offset:0
ds_read_b128 a[64:67], v28 offset:0
s_waitcnt lgkmcnt(5)
v_mfma_f32_32x32x16_bf16 v[208:223], a[224:227], a[80:83], 0
buffer_load_dwordx4 v17, s[68:71], s100 offen offset:3072 lds
ds_read_b128 a[68:71], v29 offset:0
v_mfma_f32_32x32x16_bf16 v[208:223], a[228:231], a[84:87], v[208:223]
v_cvt_pk_bf16_f32 v176, v192, v193
v_bitop3_b32 v176, s82, v105, v176 bitop3:202
v_cvt_pk_bf16_f32 v177, v194, v195
s_lshl_b32 s50, s92, 1
v_bitop3_b32 v177, s82, v105, v177 bitop3:58
s_waitcnt lgkmcnt(4)
v_mfma_f32_32x32x16_bf16 v[208:223], a[232:235], a[88:91], v[208:223]
v_cvt_pk_bf16_f32 v178, v196, v197
v_bitop3_b32 v178, s82, v105, v178 bitop3:202
v_cvt_pk_bf16_f32 v179, v198, v199
v_bitop3_b32 v179, s82, v105, v179 bitop3:58
v_cvt_pk_bf16_f32 v180, v200, v201
v_bitop3_b32 v180, s82, v105, v180 bitop3:202
v_mfma_f32_32x32x16_bf16 v[208:223], a[236:239], a[92:95], v[208:223]
s_waitcnt vmcnt(20)
s_barrier
buffer_store_dwordx4 v[176:179], v108, s[88:91], s50 offen sc1
s_waitcnt lgkmcnt(2)
v_mfma_f32_32x32x16_bf16 v[208:223], a[240:243], a[96:99], v[208:223]
ds_read_b64_tr_b16 a[72:73], v139 offset:16384
ds_read_b64_tr_b16 a[74:75], v139 offset:16896
ds_read_b64_tr_b16 a[76:77], v139 offset:17408
ds_read_b64_tr_b16 a[78:79], v139 offset:17920
v_cvt_pk_bf16_f32 v181, v202, v203
v_bitop3_b32 v181, s82, v105, v181 bitop3:58
v_cvt_pk_bf16_f32 v182, v204, v205
v_bitop3_b32 v182, s82, v105, v182 bitop3:202
v_cvt_pk_bf16_f32 v183, v206, v207
v_bitop3_b32 v183, s82, v105, v183 bitop3:58
v_mfma_f32_32x32x16_bf16 v[208:223], a[244:247], a[100:103], v[208:223]
buffer_store_dwordx4 v[180:183], v109, s[88:91], s50 offen sc1
s_waitcnt lgkmcnt(4)
v_mfma_f32_32x32x16_bf16 v[208:223], a[248:251], a[64:67], v[208:223]
ds_read_b64_tr_b16 a[80:81], v139 offset:20480
ds_read_b64_tr_b16 a[82:83], v139 offset:20992
ds_read_b64_tr_b16 a[84:85], v139 offset:21504
v_mfma_f32_32x32x16_bf16 v[208:223], a[252:255], a[68:71], v[208:223]
ds_read_b64_tr_b16 a[86:87], v139 offset:22016
ds_read_b64_tr_b16 a[88:89], v139 offset:24576
ds_read_b64_tr_b16 a[90:91], v139 offset:25088
s_waitcnt lgkmcnt(6)
v_mfma_f32_32x32x16_bf16 v[208:223], a[0:3], a[72:75], v[208:223]
s_add_u32 m0, s15, 131072
s_mov_b32 s100, s95
buffer_load_dwordx4 v18, s[72:75], s100 offen offset:0 lds
ds_read_b64_tr_b16 a[92:93], v139 offset:25600
v_mfma_f32_32x32x16_bf16 v[208:223], a[4:7], a[76:79], v[208:223]
ds_read_b64_tr_b16 a[94:95], v139 offset:26112
ds_read_b64_tr_b16 a[96:97], v139 offset:28672
ds_read_b64_tr_b16 a[98:99], v139 offset:29184
s_waitcnt lgkmcnt(6)
v_mfma_f32_32x32x16_bf16 v[208:223], a[8:11], a[80:83], v[208:223]
buffer_load_dwordx4 v19, s[72:75], s100 offen offset:1024 lds
ds_read_b64_tr_b16 a[100:101], v139 offset:29696
ds_read_b64_tr_b16 a[102:103], v139 offset:30208
v_mfma_f32_32x32x16_bf16 v[208:223], a[12:15], a[84:87], v[208:223]
s_waitcnt vmcnt(20)
s_barrier
buffer_load_dwordx4 v20, s[72:75], s100 offen offset:2048 lds
s_waitcnt lgkmcnt(4)
v_mfma_f32_32x32x16_bf16 v[208:223], a[16:19], a[88:91], v[208:223]
ds_read_b64_tr_b16 a[64:65], v46 offset:16384
ds_read_b64_tr_b16 a[66:67], v46 offset:16896
ds_read_b64_tr_b16 a[68:69], v46 offset:17408
v_mfma_f32_32x32x16_bf16 v[208:223], a[20:23], a[92:95], v[208:223]
ds_read_b64_tr_b16 a[70:71], v46 offset:17920
buffer_load_dwordx4 v21, s[72:75], s100 offen offset:3072 lds
s_waitcnt lgkmcnt(4)
v_mfma_f32_32x32x16_bf16 v[208:223], a[24:27], a[96:99], v[208:223]
ds_read_b64_tr_b16 a[72:73], v46 offset:20480
ds_read_b64_tr_b16 a[74:75], v46 offset:20992
ds_read_b64_tr_b16 a[76:77], v46 offset:21504
v_mfma_f32_32x32x16_bf16 v[208:223], a[28:31], a[100:103], v[208:223]
ds_read_b64_tr_b16 a[78:79], v46 offset:22016
ds_read_b64_tr_b16 a[80:81], v46 offset:24576
ds_read_b64_tr_b16 a[82:83], v46 offset:25088
s_waitcnt lgkmcnt(6)
v_mfma_f32_32x32x16_bf16 v[208:223], a[32:35], a[64:67], v[208:223]
s_add_u32 m0, s15, 65536
s_add_u32 s100, s95, 114688
buffer_load_dwordx4 v18, s[72:75], s100 offen offset:0 lds
ds_read_b64_tr_b16 a[84:85], v46 offset:25600
v_mfma_f32_32x32x16_bf16 v[208:223], a[36:39], a[68:71], v[208:223]
ds_read_b64_tr_b16 a[86:87], v46 offset:26112
buffer_load_dwordx4 v19, s[72:75], s100 offen offset:1024 lds
s_waitcnt lgkmcnt(4)
v_mfma_f32_32x32x16_bf16 v[208:223], a[40:43], a[72:75], v[208:223]
ds_read_b64_tr_b16 a[88:89], v46 offset:28672
ds_read_b64_tr_b16 a[90:91], v46 offset:29184
ds_read_b64_tr_b16 a[92:93], v46 offset:29696
v_mfma_f32_32x32x16_bf16 v[208:223], a[44:47], a[76:79], v[208:223]
s_waitcnt vmcnt(20)
s_barrier
ds_read_b64_tr_b16 a[94:95], v46 offset:30208
s_waitcnt lgkmcnt(4)
v_mfma_f32_32x32x16_bf16 v[208:223], a[48:51], a[80:83], v[208:223]
buffer_load_dwordx4 v20, s[72:75], s100 offen offset:2048 lds
ds_read_b128 a[96:99], v140 offset:32768
ds_read_b128 a[100:103], v23 offset:32768
v_mfma_f32_32x32x16_bf16 v[208:223], a[52:55], a[84:87], v[208:223]
buffer_load_dwordx4 v21, s[72:75], s100 offen offset:3072 lds
ds_read_b128 a[64:67], v24 offset:32768
s_waitcnt lgkmcnt(3)
v_mfma_f32_32x32x16_bf16 v[208:223], a[56:59], a[88:91], v[208:223]
s_add_u32 m0, s15, 81920
s_mul_i32 s100, s96, 448
buffer_load_dwordx4 v14, s[68:71], s100 offen offset:0 lds
ds_read_b128 a[68:71], v25 offset:32768
v_mfma_f32_32x32x16_bf16 v[208:223], a[60:63], a[92:95], v[208:223]
ds_read_b128 a[72:75], v26 offset:32768
ds_read_b128 a[76:79], v27 offset:32768
ds_read_b128 a[80:83], v28 offset:32768
s_waitcnt lgkmcnt(5)
v_mfma_f32_32x32x16_bf16 v[192:207], a[224:227], a[96:99], 0
s_lshl_b32 s13, s94, 1
buffer_load_dwordx4 v[112:115], v108, s[88:91], s13 offen sc1
buffer_load_dwordx4 v[116:119], v109, s[88:91], s13 offen sc1
v_mfma_f32_32x32x16_bf16 v[192:207], a[228:231], a[100:103], v[192:207]
ds_read_b128 a[84:87], v29 offset:32768
v_cvt_pk_bf16_f32 v176, v208, v209
v_bitop3_b32 v176, s82, v105, v176 bitop3:202
v_cvt_pk_bf16_f32 v177, v210, v211
s_lshl1_add_u32 s50, s93, 57344
s_waitcnt lgkmcnt(4)
v_mfma_f32_32x32x16_bf16 v[192:207], a[232:235], a[64:67], v[192:207]
v_bitop3_b32 v177, s82, v105, v177 bitop3:58
v_cvt_pk_bf16_f32 v178, v212, v213
v_bitop3_b32 v178, s82, v105, v178 bitop3:202
v_cvt_pk_bf16_f32 v179, v214, v215
v_bitop3_b32 v179, s82, v105, v179 bitop3:58
v_cvt_pk_bf16_f32 v180, v216, v217
v_mfma_f32_32x32x16_bf16 v[192:207], a[236:239], a[68:71], v[192:207]
s_waitcnt vmcnt(21)
s_barrier
buffer_store_dwordx4 v[176:179], v108, s[88:91], s50 offen sc1
s_waitcnt lgkmcnt(2)
v_mfma_f32_32x32x16_bf16 v[192:207], a[240:243], a[72:75], v[192:207]
ds_read_b64_tr_b16 a[88:89], v45 offset:32768
ds_read_b64_tr_b16 a[90:91], v45 offset:33280
ds_read_b64_tr_b16 a[92:93], v45 offset:33792
ds_read_b64_tr_b16 a[94:95], v45 offset:34304
v_bitop3_b32 v180, s82, v105, v180 bitop3:202
v_cvt_pk_bf16_f32 v181, v218, v219
v_bitop3_b32 v181, s82, v105, v181 bitop3:58
v_cvt_pk_bf16_f32 v182, v220, v221
v_bitop3_b32 v182, s82, v105, v182 bitop3:202
v_cvt_pk_bf16_f32 v183, v222, v223
v_bitop3_b32 v183, s82, v105, v183 bitop3:58
v_mfma_f32_32x32x16_bf16 v[192:207], a[244:247], a[76:79], v[192:207]
buffer_store_dwordx4 v[180:183], v109, s[88:91], s50 offen sc1
s_waitcnt lgkmcnt(4)
v_mfma_f32_32x32x16_bf16 v[192:207], a[248:251], a[80:83], v[192:207]
ds_read_b64_tr_b16 a[96:97], v45 offset:36864
ds_read_b64_tr_b16 a[98:99], v45 offset:37376
ds_read_b64_tr_b16 a[100:101], v45 offset:37888
v_mfma_f32_32x32x16_bf16 v[192:207], a[252:255], a[84:87], v[192:207]
ds_read_b64_tr_b16 a[102:103], v45 offset:38400
ds_read_b64_tr_b16 a[64:65], v45 offset:40960
ds_read_b64_tr_b16 a[66:67], v45 offset:41472
s_waitcnt lgkmcnt(6)
v_mfma_f32_32x32x16_bf16 v[192:207], a[0:3], a[88:91], v[192:207]
ds_read_b64_tr_b16 a[68:69], v45 offset:41984
ds_read_b64_tr_b16 a[70:71], v45 offset:42496
ds_read_b64_tr_b16 a[72:73], v45 offset:45056
v_mfma_f32_32x32x16_bf16 v[192:207], a[4:7], a[92:95], v[192:207]
buffer_load_dwordx4 v15, s[68:71], s100 offen offset:1024 lds
ds_read_b64_tr_b16 a[74:75], v45 offset:45568
s_waitcnt lgkmcnt(6)
v_mfma_f32_32x32x16_bf16 v[192:207], a[8:11], a[96:99], v[192:207]
ds_read_b64_tr_b16 a[76:77], v45 offset:46080
ds_read_b64_tr_b16 a[78:79], v45 offset:46592
v_mfma_f32_32x32x16_bf16 v[192:207], a[12:15], a[100:103], v[192:207]
s_waitcnt vmcnt(20)
s_barrier
buffer_load_dwordx4 v16, s[68:71], s100 offen offset:2048 lds
s_waitcnt lgkmcnt(4)
v_mfma_f32_32x32x16_bf16 v[192:207], a[16:19], a[64:67], v[192:207]
ds_read_b64_tr_b16 a[80:81], v139 offset:49152
ds_read_b64_tr_b16 a[82:83], v139 offset:49664
buffer_load_dwordx4 v17, s[68:71], s100 offen offset:3072 lds
v_mfma_f32_32x32x16_bf16 v[192:207], a[20:23], a[68:71], v[192:207]
ds_read_b64_tr_b16 a[84:85], v139 offset:50176
ds_read_b64_tr_b16 a[86:87], v139 offset:50688
ds_read_b64_tr_b16 a[88:89], v139 offset:53248
s_waitcnt lgkmcnt(5)
v_mfma_f32_32x32x16_bf16 v[192:207], a[24:27], a[72:75], v[192:207]
ds_read_b64_tr_b16 a[90:91], v139 offset:53760
s_add_u32 m0, s15, 0
s_mov_b32 s100, s96
buffer_load_dwordx4 v18, s[72:75], s100 offen offset:0 lds
v_mfma_f32_32x32x16_bf16 v[192:207], a[28:31], a[76:79], v[192:207]
ds_read_b64_tr_b16 a[92:93], v139 offset:54272
ds_read_b64_tr_b16 a[94:95], v139 offset:54784
ds_read_b64_tr_b16 a[96:97], v139 offset:57344
s_waitcnt lgkmcnt(5)
v_mfma_f32_32x32x16_bf16 v[192:207], a[32:35], a[80:83], v[192:207]
ds_read_b64_tr_b16 a[98:99], v139 offset:57856
buffer_load_dwordx4 v19, s[72:75], s100 offen offset:1024 lds
ds_read_b64_tr_b16 a[100:101], v139 offset:58368
v_mfma_f32_32x32x16_bf16 v[192:207], a[36:39], a[84:87], v[192:207]
ds_read_b64_tr_b16 a[102:103], v139 offset:58880
ds_read_b64_tr_b16 a[64:65], v139 offset:61440
ds_read_b64_tr_b16 a[66:67], v139 offset:61952
s_waitcnt lgkmcnt(6)
v_mfma_f32_32x32x16_bf16 v[192:207], a[40:43], a[88:91], v[192:207]
buffer_load_dwordx4 v20, s[72:75], s100 offen offset:2048 lds
ds_read_b64_tr_b16 a[68:69], v139 offset:62464
ds_read_b64_tr_b16 a[70:71], v139 offset:62976
v_mfma_f32_32x32x16_bf16 v[192:207], a[44:47], a[92:95], v[192:207]
buffer_load_dwordx4 v21, s[72:75], s100 offen offset:3072 lds
s_waitcnt lgkmcnt(4)
v_mfma_f32_32x32x16_bf16 v[192:207], a[48:51], a[96:99], v[192:207]
s_waitcnt vmcnt(10)
v_bitop3_b32 v60, v105, v112, v113 bitop3:0xbd
v_bitop3_b32 v120, v105, v114, v115 bitop3:0xbd
s_waitcnt vmcnt(9)
v_bitop3_b32 v121, v105, v116, v117 bitop3:0xbd
v_bitop3_b32 v59, v105, v118, v119 bitop3:0xbd
v_mfma_f32_32x32x16_bf16 v[192:207], a[52:55], a[100:103], v[192:207]
s_barrier
v_or3_b32 v60, v60, v120, v121
v_bitop3_b32 v60, v60, v59, s82 bitop3:0xa8
v_cmp_ne_u32 vcc, 0, v60
s_cbranch_vccnz L_rp0F
L_bp0F:
v_mfma_f32_32x32x16_bf16 v[192:207], v[96:99], v[112:115], v[192:207]
s_add_u32 m0, s15, 16384
s_add_u32 s100, s96, 114688
buffer_load_dwordx4 v18, s[72:75], s100 offen offset:0 lds
ds_read_b128 a[72:75], v30 offset:49152
v_mfma_f32_32x32x16_bf16 v[192:207], v[100:103], v[116:119], v[192:207]
ds_read_b128 a[76:79], v31 offset:49152
buffer_load_dwordx4 v19, s[72:75], s100 offen offset:1024 lds
s_waitcnt lgkmcnt(2)
v_mfma_f32_32x32x16_bf16 v[192:207], a[56:59], a[64:67], v[192:207]
ds_read_b128 a[80:83], v32 offset:49152
ds_read_b128 a[84:87], v33 offset:49152
ds_read_b128 a[88:91], v34 offset:49152
v_mfma_f32_32x32x16_bf16 v[192:207], a[60:63], a[68:71], v[192:207]
ds_read_b128 a[92:95], v39 offset:49152
ds_read_b128 a[96:99], v40 offset:49152
ds_read_b128 a[100:103], v41 offset:49152
s_waitcnt lgkmcnt(6)
v_mfma_f32_32x32x16_bf16 v[208:223], a[224:227], a[72:75], 0
s_lshl1_add_u32 s13, s95, 57344
buffer_load_dwordx4 v[122:125], v108, s[88:91], s13 offen sc1
buffer_load_dwordx4 v[126:129], v109, s[88:91], s13 offen sc1
v_mfma_f32_32x32x16_bf16 v[208:223], a[228:231], a[76:79], v[208:223]
v_cvt_pk_bf16_f32 v176, v192, v193
v_bitop3_b32 v176, s82, v106, v176 bitop3:202
v_cvt_pk_bf16_f32 v177, v194, v195
s_lshl_b32 s50, s94, 1
v_cvt_pk_bf16_f32 v178, v196, v197
s_waitcnt lgkmcnt(4)
v_mfma_f32_32x32x16_bf16 v[208:223], a[232:235], a[80:83], v[208:223]
v_cvt_pk_bf16_f32 v179, v198, v199
v_cvt_pk_bf16_f32 v180, v200, v201
v_bitop3_b32 v180, s82, v106, v180 bitop3:202
v_cvt_pk_bf16_f32 v181, v202, v203
v_cvt_pk_bf16_f32 v182, v204, v205
v_cvt_pk_bf16_f32 v183, v206, v207
v_mfma_f32_32x32x16_bf16 v[208:223], a[236:239], a[84:87], v[208:223]
s_barrier
buffer_store_dwordx4 v[176:179], v108, s[88:91], s50 offen sc1
s_waitcnt lgkmcnt(2)
v_mfma_f32_32x32x16_bf16 v[208:223], a[240:243], a[88:91], v[208:223]
ds_read_b64_tr_b16 a[64:65], v46 offset:0
ds_read_b64_tr_b16 a[66:67], v46 offset:512
ds_read_b64_tr_b16 a[68:69], v46 offset:1024
ds_read_b64_tr_b16 a[70:71], v46 offset:1536
v_mfma_f32_32x32x16_bf16 v[208:223], a[244:247], a[92:95], v[208:223]
buffer_store_dwordx4 v[180:183], v109, s[88:91], s50 offen sc1
s_waitcnt lgkmcnt(4)
v_mfma_f32_32x32x16_bf16 v[208:223], a[248:251], a[96:99], v[208:223]
ds_read_b64_tr_b16 a[72:73], v46 offset:4096
ds_read_b64_tr_b16 a[74:75], v46 offset:4608
ds_read_b64_tr_b16 a[76:77], v46 offset:5120
v_mfma_f32_32x32x16_bf16 v[208:223], a[252:255], a[100:103], v[208:223]
ds_read_b64_tr_b16 a[78:79], v46 offset:5632
ds_read_b64_tr_b16 a[80:81], v46 offset:8192
ds_read_b64_tr_b16 a[82:83], v46 offset:8704
s_waitcnt lgkmcnt(6)
v_mfma_f32_32x32x16_bf16 v[208:223], a[0:3], a[64:67], v[208:223]
buffer_load_dwordx4 v20, s[72:75], s100 offen offset:2048 lds
ds_read_b64_tr_b16 a[84:85], v46 offset:9216
ds_read_b64_tr_b16 a[86:87], v46 offset:9728
v_mfma_f32_32x32x16_bf16 v[208:223], a[4:7], a[68:71], v[208:223]
ds_read_b64_tr_b16 a[88:89], v46 offset:12288
ds_read_b64_tr_b16 a[90:91], v46 offset:12800
ds_read_b64_tr_b16 a[92:93], v46 offset:13312
s_waitcnt lgkmcnt(7)
v_mfma_f32_32x32x16_bf16 v[208:223], a[8:11], a[72:75], v[208:223]
buffer_load_dwordx4 v21, s[72:75], s100 offen offset:3072 lds
ds_read_b64_tr_b16 a[94:95], v46 offset:13824
v_mfma_f32_32x32x16_bf16 v[208:223], a[12:15], a[76:79], v[208:223]
s_barrier
ds_read_b64_tr_b16 a[96:97], v45 offset:0
s_waitcnt lgkmcnt(5)
v_mfma_f32_32x32x16_bf16 v[208:223], a[16:19], a[80:83], v[208:223]
ds_read_b64_tr_b16 a[98:99], v45 offset:512
s_add_u32 m0, s15, 32768
s_mul_i32 s100, s97, 448
buffer_load_dwordx4 v14, s[68:71], s100 offen offset:0 lds
v_mfma_f32_32x32x16_bf16 v[208:223], a[20:23], a[84:87], v[208:223]
ds_read_b64_tr_b16 a[100:101], v45 offset:1024
ds_read_b64_tr_b16 a[102:103], v45 offset:1536
ds_read_b64_tr_b16 a[64:65], v45 offset:4096
s_waitcnt lgkmcnt(5)
v_mfma_f32_32x32x16_bf16 v[208:223], a[24:27], a[88:91], v[208:223]
ds_read_b64_tr_b16 a[66:67], v45 offset:4608
buffer_load_dwordx4 v15, s[68:71], s100 offen offset:1024 lds
ds_read_b64_tr_b16 a[68:69], v45 offset:5120
v_mfma_f32_32x32x16_bf16 v[208:223], a[28:31], a[92:95], v[208:223]
ds_read_b64_tr_b16 a[70:71], v45 offset:5632
ds_read_b64_tr_b16 a[72:73], v45 offset:8192
ds_read_b64_tr_b16 a[74:75], v45 offset:8704
s_waitcnt lgkmcnt(6)
v_mfma_f32_32x32x16_bf16 v[208:223], a[32:35], a[96:99], v[208:223]
buffer_load_dwordx4 v16, s[68:71], s100 offen offset:2048 lds
ds_read_b64_tr_b16 a[76:77], v45 offset:9216
ds_read_b64_tr_b16 a[78:79], v45 offset:9728
v_mfma_f32_32x32x16_bf16 v[208:223], a[36:39], a[100:103], v[208:223]
buffer_load_dwordx4 v17, s[68:71], s100 offen offset:3072 lds
ds_read_b64_tr_b16 a[80:81], v45 offset:12288
s_waitcnt lgkmcnt(5)
v_mfma_f32_32x32x16_bf16 v[208:223], a[40:43], a[64:67], v[208:223]
ds_read_b64_tr_b16 a[82:83], v45 offset:12800
ds_read_b64_tr_b16 a[84:85], v45 offset:13312
ds_read_b64_tr_b16 a[86:87], v45 offset:13824
v_mfma_f32_32x32x16_bf16 v[208:223], a[44:47], a[68:71], v[208:223]
s_add_u32 m0, s15, 147456
s_mov_b32 s100, s97
buffer_load_dwordx4 v18, s[72:75], s100 offen offset:0 lds
s_waitcnt lgkmcnt(4)
v_mfma_f32_32x32x16_bf16 v[208:223], a[48:51], a[72:75], v[208:223]
s_waitcnt vmcnt(10)
v_bitop3_b32 v60, v105, v122, v123 bitop3:0xbd
v_bitop3_b32 v130, v105, v124, v125 bitop3:0xbd
s_waitcnt vmcnt(9)
v_bitop3_b32 v131, v105, v126, v127 bitop3:0xbd
v_bitop3_b32 v59, v105, v128, v129 bitop3:0xbd
v_mfma_f32_32x32x16_bf16 v[208:223], a[52:55], a[76:79], v[208:223]
s_barrier
v_or3_b32 v60, v60, v130, v131
v_bitop3_b32 v60, v60, v59, s82 bitop3:0xa8
v_cmp_ne_u32 vcc, 0, v60
s_cbranch_vccnz L_rp1F
L_bp1F:
v_mfma_f32_32x32x16_bf16 v[208:223], v[96:99], v[122:125], v[208:223]
buffer_load_dwordx4 v19, s[72:75], s100 offen offset:1024 lds
ds_read_b128 a[88:91], v30 offset:16384
ds_read_b128 a[92:95], v31 offset:16384
v_mfma_f32_32x32x16_bf16 v[208:223], v[100:103], v[126:129], v[208:223]
buffer_load_dwordx4 v20, s[72:75], s100 offen offset:2048 lds
ds_read_b128 a[96:99], v32 offset:16384
s_waitcnt lgkmcnt(3)
v_mfma_f32_32x32x16_bf16 v[208:223], a[56:59], a[80:83], v[208:223]
buffer_load_dwordx4 v21, s[72:75], s100 offen offset:3072 lds
ds_read_b128 a[100:103], v33 offset:16384
ds_read_b128 a[64:67], v34 offset:16384
v_mfma_f32_32x32x16_bf16 v[208:223], a[60:63], a[84:87], v[208:223]
ds_read_b128 a[68:71], v39 offset:16384
ds_read_b128 a[72:75], v40 offset:16384
ds_read_b128 a[76:79], v41 offset:16384
s_waitcnt lgkmcnt(6)
v_mfma_f32_32x32x16_bf16 v[192:207], a[224:227], a[88:91], 0
s_lshl_b32 s13, s96, 1
buffer_load_dwordx4 v[144:147], v108, s[88:91], s13 offen sc1
buffer_load_dwordx4 v[148:151], v109, s[88:91], s13 offen sc1
v_mfma_f32_32x32x16_bf16 v[192:207], a[228:231], a[92:95], v[192:207]
v_cvt_pk_bf16_f32 v176, v208, v209
v_cvt_pk_bf16_f32 v177, v210, v211
s_lshl1_add_u32 s50, s95, 57344
v_cvt_pk_bf16_f32 v178, v212, v213
v_bitop3_b32 v178, s82, v106, v178 bitop3:202
s_waitcnt lgkmcnt(4)
v_mfma_f32_32x32x16_bf16 v[192:207], a[232:235], a[96:99], v[192:207]
v_cvt_pk_bf16_f32 v179, v214, v215
v_cvt_pk_bf16_f32 v180, v216, v217
v_cvt_pk_bf16_f32 v181, v218, v219
v_cvt_pk_bf16_f32 v182, v220, v221
v_bitop3_b32 v182, s82, v106, v182 bitop3:202
v_cvt_pk_bf16_f32 v183, v222, v223
v_mfma_f32_32x32x16_bf16 v[192:207], a[236:239], a[100:103], v[192:207]
s_barrier
buffer_store_dwordx4 v[176:179], v108, s[88:91], s50 offen sc1
s_waitcnt lgkmcnt(2)
v_mfma_f32_32x32x16_bf16 v[192:207], a[240:243], a[64:67], v[192:207]
ds_read_b64_tr_b16 a[80:81], v139 offset:0
ds_read_b64_tr_b16 a[82:83], v139 offset:512
ds_read_b64_tr_b16 a[84:85], v139 offset:1024
ds_read_b64_tr_b16 a[86:87], v139 offset:1536
v_mfma_f32_32x32x16_bf16 v[192:207], a[244:247], a[68:71], v[192:207]
buffer_store_dwordx4 v[180:183], v109, s[88:91], s50 offen sc1
s_waitcnt lgkmcnt(4)
v_mfma_f32_32x32x16_bf16 v[192:207], a[248:251], a[72:75], v[192:207]
ds_read_b64_tr_b16 a[88:89], v139 offset:4096
ds_read_b64_tr_b16 a[90:91], v139 offset:4608
ds_read_b64_tr_b16 a[92:93], v139 offset:5120
s_movk_i32 s34, 0
v_mfma_f32_32x32x16_bf16 v[192:207], a[252:255], a[76:79], v[192:207]
ds_read_b64_tr_b16 a[94:95], v139 offset:5632
ds_read_b64_tr_b16 a[96:97], v139 offset:8192
ds_read_b64_tr_b16 a[98:99], v139 offset:8704
s_waitcnt lgkmcnt(6)
v_mfma_f32_32x32x16_bf16 v[192:207], a[0:3], a[80:83], v[192:207]
ds_read_b64_tr_b16 a[100:101], v139 offset:9216
ds_read_b64_tr_b16 a[102:103], v139 offset:9728
ds_read_b64_tr_b16 a[64:65], v139 offset:12288
s_movk_i32 s35, 3584
v_mfma_f32_32x32x16_bf16 v[192:207], a[4:7], a[84:87], v[192:207]
s_add_u32 m0, s15, 98304
s_add_u32 s100, s97, 114688
buffer_load_dwordx4 v18, s[72:75], s100 offen offset:0 lds
s_movk_i32 s36, 7168
s_waitcnt lgkmcnt(5)
v_mfma_f32_32x32x16_bf16 v[192:207], a[8:11], a[88:91], v[192:207]
ds_read_b64_tr_b16 a[66:67], v139 offset:12800
ds_read_b64_tr_b16 a[68:69], v139 offset:13312
ds_read_b64_tr_b16 a[70:71], v139 offset:13824
s_movk_i32 s37, 10752
v_mfma_f32_32x32x16_bf16 v[192:207], a[12:15], a[92:95], v[192:207]
s_waitcnt vmcnt(13)
s_barrier
buffer_load_dwordx4 v19, s[72:75], s100 offen offset:1024 lds
s_waitcnt lgkmcnt(4)
v_mfma_f32_32x32x16_bf16 v[192:207], a[16:19], a[96:99], v[192:207]
ds_read_b64_tr_b16 a[72:73], v139 offset:16384
ds_read_b64_tr_b16 a[74:75], v139 offset:16896
ds_read_b64_tr_b16 a[76:77], v139 offset:17408
s_movk_i32 s38, 14336
v_mfma_f32_32x32x16_bf16 v[192:207], a[20:23], a[100:103], v[192:207]
ds_read_b64_tr_b16 a[78:79], v139 offset:17920
buffer_load_dwordx4 v20, s[72:75], s100 offen offset:2048 lds
s_movk_i32 s39, 17920
s_waitcnt lgkmcnt(4)
v_mfma_f32_32x32x16_bf16 v[192:207], a[24:27], a[64:67], v[192:207]
ds_read_b64_tr_b16 a[80:81], v139 offset:20480
ds_read_b64_tr_b16 a[82:83], v139 offset:20992
buffer_load_dwordx4 v21, s[72:75], s100 offen offset:3072 lds
v_mfma_f32_32x32x16_bf16 v[192:207], a[28:31], a[68:71], v[192:207]
ds_read_b64_tr_b16 a[84:85], v139 offset:21504
ds_read_b64_tr_b16 a[86:87], v139 offset:22016
ds_read_b64_tr_b16 a[88:89], v139 offset:24576
s_waitcnt lgkmcnt(5)
v_mfma_f32_32x32x16_bf16 v[192:207], a[32:35], a[72:75], v[192:207]
ds_read_b64_tr_b16 a[90:91], v139 offset:25088
s_add_u32 m0, s15, 49152
s_mul_i32 s100, s98, 448
buffer_load_dwordx4 v14, s[68:71], s100 offen offset:0 lds
v_mfma_f32_32x32x16_bf16 v[192:207], a[36:39], a[76:79], v[192:207]
ds_read_b64_tr_b16 a[92:93], v139 offset:25600
ds_read_b64_tr_b16 a[94:95], v139 offset:26112
ds_read_b64_tr_b16 a[96:97], v139 offset:28672
s_waitcnt lgkmcnt(5)
v_mfma_f32_32x32x16_bf16 v[192:207], a[40:43], a[80:83], v[192:207]
buffer_load_dwordx4 v15, s[68:71], s100 offen offset:1024 lds
ds_read_b64_tr_b16 a[98:99], v139 offset:29184
ds_read_b64_tr_b16 a[100:101], v139 offset:29696
v_mfma_f32_32x32x16_bf16 v[192:207], a[44:47], a[84:87], v[192:207]
ds_read_b64_tr_b16 a[102:103], v139 offset:30208
s_movk_i32 s40, 21504
s_movk_i32 s41, 25088
s_waitcnt lgkmcnt(4)
v_mfma_f32_32x32x16_bf16 v[192:207], a[48:51], a[88:91], v[192:207]
s_waitcnt vmcnt(8)
v_bitop3_b32 v60, v106, v144, v148 bitop3:0x7e
v_and_b32 v60, s82, v60
buffer_load_dwordx4 v16, s[68:71], s100 offen offset:2048 lds
v_mfma_f32_32x32x16_bf16 v[192:207], a[52:55], a[92:95], v[192:207]
s_barrier
v_cmp_ne_u32 vcc, 0, v60
s_cbranch_vccnz L_rp2F
L_bp2F:
v_mfma_f32_32x32x16_bf16 v[192:207], v[96:99], v[144:147], v[192:207]
ds_read_b128 a[64:67], v140 offset:32768
buffer_load_dwordx4 v17, s[68:71], s100 offen offset:3072 lds
ds_read_b128 a[68:71], v23 offset:32768
v_mfma_f32_32x32x16_bf16 v[192:207], v[100:103], v[148:151], v[192:207]
s_add_u32 m0, s15, 114688
s_mov_b32 s100, s98
buffer_load_dwordx4 v18, s[72:75], s100 offen offset:0 lds
s_waitcnt lgkmcnt(2)
v_mfma_f32_32x32x16_bf16 v[192:207], a[56:59], a[96:99], v[192:207]
ds_read_b128 a[72:75], v24 offset:32768
ds_read_b128 a[76:79], v25 offset:32768
ds_read_b128 a[80:83], v26 offset:32768
v_mfma_f32_32x32x16_bf16 v[192:207], a[60:63], a[100:103], v[192:207]
ds_read_b128 a[84:87], v27 offset:32768
ds_read_b128 a[88:91], v28 offset:32768
ds_read_b128 a[92:95], v29 offset:32768
s_waitcnt lgkmcnt(6)
v_mfma_f32_32x32x16_bf16 v[208:223], a[224:227], a[64:67], 0
s_lshl1_add_u32 s13, s97, 57344
buffer_load_dwordx4 v[154:157], v108, s[88:91], s13 offen sc1
buffer_load_dwordx4 v[158:161], v109, s[88:91], s13 offen sc1
v_mfma_f32_32x32x16_bf16 v[208:223], a[228:231], a[68:71], v[208:223]
v_cvt_pk_bf16_f32 v176, v192, v193
v_bitop3_b32 v176, s82, v107, v176 bitop3:202
v_cvt_pk_bf16_f32 v177, v194, v195
s_lshl_b32 s50, s96, 1
v_cvt_pk_bf16_f32 v178, v196, v197
s_waitcnt lgkmcnt(4)
v_mfma_f32_32x32x16_bf16 v[208:223], a[232:235], a[72:75], v[208:223]
v_cvt_pk_bf16_f32 v179, v198, v199
v_cvt_pk_bf16_f32 v180, v200, v201
v_bitop3_b32 v180, s82, v107, v180 bitop3:202
v_cvt_pk_bf16_f32 v181, v202, v203
v_cvt_pk_bf16_f32 v182, v204, v205
v_cvt_pk_bf16_f32 v183, v206, v207
v_mfma_f32_32x32x16_bf16 v[208:223], a[236:239], a[76:79], v[208:223]
s_barrier
buffer_store_dwordx4 v[176:179], v108, s[88:91], s50 offen sc1
s_waitcnt lgkmcnt(2)
v_mfma_f32_32x32x16_bf16 v[208:223], a[240:243], a[80:83], v[208:223]
ds_read_b64_tr_b16 a[96:97], v46 offset:16384
ds_read_b64_tr_b16 a[98:99], v46 offset:16896
ds_read_b64_tr_b16 a[100:101], v46 offset:17408
ds_read_b64_tr_b16 a[102:103], v46 offset:17920
v_mfma_f32_32x32x16_bf16 v[208:223], a[244:247], a[84:87], v[208:223]
buffer_store_dwordx4 v[180:183], v109, s[88:91], s50 offen sc1
s_waitcnt lgkmcnt(4)
v_mfma_f32_32x32x16_bf16 v[208:223], a[248:251], a[88:91], v[208:223]
ds_read_b64_tr_b16 a[64:65], v46 offset:20480
ds_read_b64_tr_b16 a[66:67], v46 offset:20992
ds_read_b64_tr_b16 a[68:69], v46 offset:21504
v_mfma_f32_32x32x16_bf16 v[208:223], a[252:255], a[92:95], v[208:223]
ds_read_b64_tr_b16 a[70:71], v46 offset:22016
ds_read_b64_tr_b16 a[72:73], v46 offset:24576
ds_read_b64_tr_b16 a[74:75], v46 offset:25088
s_waitcnt lgkmcnt(6)
v_mfma_f32_32x32x16_bf16 v[208:223], a[0:3], a[96:99], v[208:223]
buffer_load_dwordx4 v19, s[72:75], s100 offen offset:1024 lds
ds_read_b64_tr_b16 a[76:77], v46 offset:25600
ds_read_b64_tr_b16 a[78:79], v46 offset:26112
v_mfma_f32_32x32x16_bf16 v[208:223], a[4:7], a[100:103], v[208:223]
ds_read_b64_tr_b16 a[80:81], v46 offset:28672
ds_read_b64_tr_b16 a[82:83], v46 offset:29184
ds_read_b64_tr_b16 a[84:85], v46 offset:29696
s_waitcnt lgkmcnt(7)
v_mfma_f32_32x32x16_bf16 v[208:223], a[8:11], a[64:67], v[208:223]
buffer_load_dwordx4 v20, s[72:75], s100 offen offset:2048 lds
ds_read_b64_tr_b16 a[86:87], v46 offset:30208
v_mfma_f32_32x32x16_bf16 v[208:223], a[12:15], a[68:71], v[208:223]
s_waitcnt vmcnt(11)
s_barrier
ds_read_b64_tr_b16 a[88:89], v45 offset:32768
s_waitcnt lgkmcnt(5)
v_mfma_f32_32x32x16_bf16 v[208:223], a[16:19], a[72:75], v[208:223]
ds_read_b64_tr_b16 a[90:91], v45 offset:33280
buffer_load_dwordx4 v21, s[72:75], s100 offen offset:3072 lds
ds_read_b64_tr_b16 a[92:93], v45 offset:33792
v_mfma_f32_32x32x16_bf16 v[208:223], a[20:23], a[76:79], v[208:223]
ds_read_b64_tr_b16 a[94:95], v45 offset:34304
ds_read_b64_tr_b16 a[96:97], v45 offset:36864
ds_read_b64_tr_b16 a[98:99], v45 offset:37376
s_waitcnt lgkmcnt(6)
v_mfma_f32_32x32x16_bf16 v[208:223], a[24:27], a[80:83], v[208:223]
s_add_u32 m0, s15, 131072
s_add_u32 s100, s98, 114688
buffer_load_dwordx4 v18, s[72:75], s100 offen offset:0 lds
ds_read_b64_tr_b16 a[100:101], v45 offset:37888
v_mfma_f32_32x32x16_bf16 v[208:223], a[28:31], a[84:87], v[208:223]
ds_read_b64_tr_b16 a[102:103], v45 offset:38400
ds_read_b64_tr_b16 a[64:65], v45 offset:40960
ds_read_b64_tr_b16 a[66:67], v45 offset:41472
s_waitcnt lgkmcnt(6)
v_mfma_f32_32x32x16_bf16 v[208:223], a[32:35], a[88:91], v[208:223]
buffer_load_dwordx4 v19, s[72:75], s100 offen offset:1024 lds
ds_read_b64_tr_b16 a[68:69], v45 offset:41984
ds_read_b64_tr_b16 a[70:71], v45 offset:42496
v_mfma_f32_32x32x16_bf16 v[208:223], a[36:39], a[92:95], v[208:223]
buffer_load_dwordx4 v20, s[72:75], s100 offen offset:2048 lds
ds_read_b64_tr_b16 a[72:73], v45 offset:45056
s_waitcnt lgkmcnt(5)
v_mfma_f32_32x32x16_bf16 v[208:223], a[40:43], a[96:99], v[208:223]
ds_read_b64_tr_b16 a[74:75], v45 offset:45568
ds_read_b64_tr_b16 a[76:77], v45 offset:46080
ds_read_b64_tr_b16 a[78:79], v45 offset:46592
v_mfma_f32_32x32x16_bf16 v[208:223], a[44:47], a[100:103], v[208:223]
buffer_load_dwordx4 v21, s[72:75], s100 offen offset:3072 lds
s_waitcnt lgkmcnt(4)
v_mfma_f32_32x32x16_bf16 v[208:223], a[48:51], a[64:67], v[208:223]
s_waitcnt vmcnt(9)
v_bitop3_b32 v60, v106, v156, v160 bitop3:0x7e
v_and_b32 v60, s82, v60
v_mfma_f32_32x32x16_bf16 v[208:223], a[52:55], a[68:71], v[208:223]
s_barrier
v_cmp_ne_u32 vcc, 0, v60
s_cbranch_vccnz L_rp3F
L_bp3F:
v_mfma_f32_32x32x16_bf16 v[208:223], v[96:99], v[154:157], v[208:223]
ds_read_b128 a[80:83], v140 offset:49152
ds_read_b128 a[84:87], v23 offset:49152
ds_read_b128 a[88:91], v24 offset:49152
v_mfma_f32_32x32x16_bf16 v[208:223], v[100:103], v[158:161], v[208:223]
ds_read_b128 a[92:95], v25 offset:49152
ds_read_b128 a[96:99], v26 offset:49152
ds_read_b128 a[100:103], v27 offset:49152
s_waitcnt lgkmcnt(6)
v_mfma_f32_32x32x16_bf16 v[208:223], a[56:59], a[72:75], v[208:223]
ds_read_b128 a[64:67], v28 offset:49152
ds_read_b128 a[68:71], v29 offset:49152
v_mfma_f32_32x32x16_bf16 v[208:223], a[60:63], a[76:79], v[208:223]
s_waitcnt lgkmcnt(6)
v_mfma_f32_32x32x16_bf16 v[64:79], a[224:227], a[80:83], v[64:79]
s_lshl_b32 s13, s98, 1
buffer_load_dwordx4 v[164:167], v108, s[88:91], s13 offen sc1
buffer_load_dwordx4 v[168:171], v109, s[88:91], s13 offen sc1
v_mfma_f32_32x32x16_bf16 v[64:79], a[228:231], a[84:87], v[64:79]
v_cvt_pk_bf16_f32 v176, v208, v209
v_cvt_pk_bf16_f32 v177, v210, v211
s_lshl1_add_u32 s50, s97, 57344
v_cvt_pk_bf16_f32 v178, v212, v213
v_bitop3_b32 v178, s82, v107, v178 bitop3:202
s_waitcnt lgkmcnt(4)
v_mfma_f32_32x32x16_bf16 v[64:79], a[232:235], a[88:91], v[64:79]
v_cvt_pk_bf16_f32 v179, v214, v215
v_cvt_pk_bf16_f32 v180, v216, v217
v_cvt_pk_bf16_f32 v181, v218, v219
v_cvt_pk_bf16_f32 v182, v220, v221
v_bitop3_b32 v182, s82, v107, v182 bitop3:202
v_cvt_pk_bf16_f32 v183, v222, v223
v_mfma_f32_32x32x16_bf16 v[64:79], a[236:239], a[92:95], v[64:79]
s_waitcnt vmcnt(6)
s_barrier
buffer_store_dwordx4 v[176:179], v108, s[88:91], s50 offen sc1
s_waitcnt lgkmcnt(2)
v_mfma_f32_32x32x16_bf16 v[64:79], a[240:243], a[96:99], v[64:79]
ds_read_b64_tr_b16 a[72:73], v45 offset:49152
ds_read_b64_tr_b16 a[74:75], v45 offset:49664
ds_read_b64_tr_b16 a[76:77], v45 offset:50176
ds_read_b64_tr_b16 a[78:79], v45 offset:50688
v_mfma_f32_32x32x16_bf16 v[64:79], a[244:247], a[100:103], v[64:79]
buffer_store_dwordx4 v[180:183], v109, s[88:91], s50 offen sc1
s_waitcnt lgkmcnt(4)
v_mfma_f32_32x32x16_bf16 v[64:79], a[248:251], a[64:67], v[64:79]
ds_read_b64_tr_b16 a[80:81], v45 offset:53248
ds_read_b64_tr_b16 a[82:83], v45 offset:53760
ds_read_b64_tr_b16 a[84:85], v45 offset:54272
v_mfma_f32_32x32x16_bf16 v[64:79], a[252:255], a[68:71], v[64:79]
ds_read_b64_tr_b16 a[86:87], v45 offset:54784
ds_read_b64_tr_b16 a[88:89], v45 offset:57344
ds_read_b64_tr_b16 a[90:91], v45 offset:57856
s_waitcnt lgkmcnt(6)
v_mfma_f32_32x32x16_bf16 v[64:79], a[0:3], a[72:75], v[64:79]
ds_read_b64_tr_b16 a[92:93], v45 offset:58368
ds_read_b64_tr_b16 a[94:95], v45 offset:58880
ds_read_b64_tr_b16 a[96:97], v45 offset:61440
v_mfma_f32_32x32x16_bf16 v[64:79], a[4:7], a[76:79], v[64:79]
ds_read_b64_tr_b16 a[98:99], v45 offset:61952
ds_read_b64_tr_b16 a[100:101], v45 offset:62464
ds_read_b64_tr_b16 a[102:103], v45 offset:62976
s_waitcnt lgkmcnt(8)
v_mfma_f32_32x32x16_bf16 v[64:79], a[8:11], a[80:83], v[64:79]
v_mfma_f32_32x32x16_bf16 v[64:79], a[12:15], a[84:87], v[64:79]
s_waitcnt vmcnt(4)
s_barrier
ds_read_b64_tr_b16 a[64:65], v46 offset:0
s_waitcnt lgkmcnt(5)
v_mfma_f32_32x32x16_bf16 v[64:79], a[16:19], a[88:91], v[64:79]
ds_read_b64_tr_b16 a[66:67], v46 offset:512
ds_read_b64_tr_b16 a[68:69], v46 offset:1024
ds_read_b64_tr_b16 a[70:71], v46 offset:1536
v_mfma_f32_32x32x16_bf16 v[64:79], a[20:23], a[92:95], v[64:79]
ds_read_b64_tr_b16 a[72:73], v46 offset:4096
ds_read_b64_tr_b16 a[74:75], v46 offset:4608
ds_read_b64_tr_b16 a[76:77], v46 offset:5120
s_waitcnt lgkmcnt(7)
v_mfma_f32_32x32x16_bf16 v[64:79], a[24:27], a[96:99], v[64:79]
ds_read_b64_tr_b16 a[78:79], v46 offset:5632
ds_read_b64_tr_b16 a[80:81], v46 offset:8192
ds_read_b64_tr_b16 a[82:83], v46 offset:8704
v_mfma_f32_32x32x16_bf16 v[64:79], a[28:31], a[100:103], v[64:79]
ds_read_b64_tr_b16 a[84:85], v46 offset:9216
ds_read_b64_tr_b16 a[86:87], v46 offset:9728
ds_read_b64_tr_b16 a[88:89], v46 offset:12288
s_waitcnt lgkmcnt(9)
v_mfma_f32_32x32x16_bf16 v[64:79], a[32:35], a[64:67], v[64:79]
s_lshl1_add_u32 s13, s98, 57344
buffer_load_dwordx4 v[224:227], v108, s[88:91], s13 offen sc1
buffer_load_dwordx4 v[228:231], v109, s[88:91], s13 offen sc1
v_mfma_f32_32x32x16_bf16 v[64:79], a[36:39], a[68:71], v[64:79]
ds_read_b64_tr_b16 a[90:91], v46 offset:12800
ds_read_b64_tr_b16 a[92:93], v46 offset:13312
ds_read_b64_tr_b16 a[94:95], v46 offset:13824
s_waitcnt lgkmcnt(8)
v_mfma_f32_32x32x16_bf16 v[64:79], a[40:43], a[72:75], v[64:79]
v_mfma_f32_32x32x16_bf16 v[64:79], a[44:47], a[76:79], v[64:79]
s_waitcnt lgkmcnt(4)
v_mfma_f32_32x32x16_bf16 v[64:79], a[48:51], a[80:83], v[64:79]
s_waitcnt vmcnt(4)
v_bitop3_b32 v60, v107, v164, v168 bitop3:0x7e
v_and_b32 v60, s82, v60
v_mfma_f32_32x32x16_bf16 v[64:79], a[52:55], a[84:87], v[64:79]
v_cmp_ne_u32 vcc, 0, v60
s_cbranch_vccnz L_rp4F
L_bp4F:
v_mfma_f32_32x32x16_bf16 v[64:79], v[96:99], v[164:167], v[64:79]
v_mfma_f32_32x32x16_bf16 v[64:79], v[100:103], v[168:171], v[64:79]
s_waitcnt lgkmcnt(0)
v_mfma_f32_32x32x16_bf16 v[64:79], a[56:59], a[88:91], v[64:79]
v_mfma_f32_32x32x16_bf16 v[64:79], a[60:63], a[92:95], v[64:79]
s_waitcnt vmcnt(0)
v_bitop3_b32 v60, v107, v226, v230 bitop3:0x7e
v_and_b32 v60, s82, v60
v_cmp_ne_u32 vcc, 0, v60
s_cbranch_vccnz L_rp5F
L_bp5F:
v_mfma_f32_32x32x16_bf16 v[64:79], v[96:99], v[224:227], v[64:79]
v_mfma_f32_32x32x16_bf16 v[64:79], v[100:103], v[228:231], v[64:79]
s_nop 11
v_pk_mul_f32 v[64:65], v[64:65], v[80:81]
v_pk_mul_f32 v[66:67], v[66:67], v[82:83]
v_pk_mul_f32 v[68:69], v[68:69], v[84:85]
v_pk_mul_f32 v[70:71], v[70:71], v[86:87]
v_pk_mul_f32 v[72:73], v[72:73], v[88:89]
v_pk_mul_f32 v[74:75], v[74:75], v[90:91]
v_pk_mul_f32 v[76:77], v[76:77], v[92:93]
v_pk_mul_f32 v[78:79], v[78:79], v[94:95]
buffer_store_dword v64, v110, s[88:91], s34 offen offset:0
buffer_store_dword v65, v110, s[88:91], s34 offen offset:1792
buffer_store_dword v66, v110, s[88:91], s35 offen offset:0
buffer_store_dword v67, v110, s[88:91], s35 offen offset:1792
buffer_store_dword v68, v110, s[88:91], s36 offen offset:0
buffer_store_dword v69, v110, s[88:91], s36 offen offset:1792
buffer_store_dword v70, v110, s[88:91], s37 offen offset:0
buffer_store_dword v71, v110, s[88:91], s37 offen offset:1792
buffer_store_dword v72, v110, s[88:91], s38 offen offset:0
buffer_store_dword v73, v110, s[88:91], s38 offen offset:1792
buffer_store_dword v74, v110, s[88:91], s39 offen offset:0
buffer_store_dword v75, v110, s[88:91], s39 offen offset:1792
buffer_store_dword v76, v110, s[88:91], s40 offen offset:0
buffer_store_dword v77, v110, s[88:91], s40 offen offset:1792
buffer_store_dword v78, v110, s[88:91], s41 offen offset:0
buffer_store_dword v79, v110, s[88:91], s41 offen offset:1792
s_lshl_b32 s50, s12, 2
s_add_u32 s50, s50, s3
s_lshl_b32 s50, s50, 5
s_add_u32 s50, s50, s11
s_cmp_lg_u32 s50, 31
s_cbranch_scc1 L_exitF
v_mov_b32 v0, 0
global_store_dword v0, v104, s[48:49] sc1
L_exitF:
s_endpgm
L_rp0F:
s_lshl_b32 s51, s94, 1
buffer_load_dwordx4 v[112:115], v108, s[88:91], s51 offen sc1
buffer_load_dwordx4 v[116:119], v109, s[88:91], s51 offen sc1
s_add_u32 s99, s99, 1
s_waitcnt vmcnt(0)
s_cmp_gt_u32 s99, 0x8000
s_cbranch_scc1 L_bp0F
v_bitop3_b32 v60, v105, v112, v113 bitop3:0xbd
v_bitop3_b32 v120, v105, v114, v115 bitop3:0xbd
v_bitop3_b32 v121, v105, v116, v117 bitop3:0xbd
v_bitop3_b32 v59, v105, v118, v119 bitop3:0xbd
v_or3_b32 v60, v60, v120, v121
v_bitop3_b32 v60, v60, v59, s82 bitop3:0xa8
v_cmp_ne_u32 vcc, 0, v60
s_cbranch_vccnz L_rp0F
s_branch L_bp0F
L_rp1F:
s_lshl1_add_u32 s51, s95, 57344
buffer_load_dwordx4 v[122:125], v108, s[88:91], s51 offen sc1
buffer_load_dwordx4 v[126:129], v109, s[88:91], s51 offen sc1
s_add_u32 s99, s99, 1
s_waitcnt vmcnt(0)
s_cmp_gt_u32 s99, 0x8000
s_cbranch_scc1 L_bp1F
v_bitop3_b32 v60, v105, v122, v123 bitop3:0xbd
v_bitop3_b32 v130, v105, v124, v125 bitop3:0xbd
v_bitop3_b32 v131, v105, v126, v127 bitop3:0xbd
v_bitop3_b32 v59, v105, v128, v129 bitop3:0xbd
v_or3_b32 v60, v60, v130, v131
v_bitop3_b32 v60, v60, v59, s82 bitop3:0xa8
v_cmp_ne_u32 vcc, 0, v60
s_cbranch_vccnz L_rp1F
s_branch L_bp1F
L_rp2F:
s_lshl_b32 s51, s96, 1
buffer_load_dwordx4 v[144:147], v108, s[88:91], s51 offen sc1
buffer_load_dwordx4 v[148:151], v109, s[88:91], s51 offen sc1
s_add_u32 s99, s99, 1
s_waitcnt vmcnt(0)
s_cmp_gt_u32 s99, 0x8000
s_cbranch_scc1 L_bp2F
v_bitop3_b32 v60, v106, v144, v148 bitop3:0x7e
v_and_b32 v60, s82, v60
v_cmp_ne_u32 vcc, 0, v60
s_cbranch_vccnz L_rp2F
s_branch L_bp2F
L_rp3F:
s_lshl1_add_u32 s51, s97, 57344
buffer_load_dwordx4 v[154:157], v108, s[88:91], s51 offen sc1
buffer_load_dwordx4 v[158:161], v109, s[88:91], s51 offen sc1
s_add_u32 s99, s99, 1
s_waitcnt vmcnt(0)
s_cmp_gt_u32 s99, 0x8000
s_cbranch_scc1 L_bp3F
v_bitop3_b32 v60, v106, v156, v160 bitop3:0x7e
v_and_b32 v60, s82, v60
v_cmp_ne_u32 vcc, 0, v60
s_cbranch_vccnz L_rp3F
s_branch L_bp3F
L_rp4F:
s_lshl_b32 s51, s98, 1
buffer_load_dwordx4 v[164:167], v108, s[88:91], s51 offen sc1
buffer_load_dwordx4 v[168:171], v109, s[88:91], s51 offen sc1
s_add_u32 s99, s99, 1
s_waitcnt vmcnt(0)
s_cmp_gt_u32 s99, 0x8000
s_cbranch_scc1 L_bp4F
v_bitop3_b32 v60, v107, v164, v168 bitop3:0x7e
v_and_b32 v60, s82, v60
v_cmp_ne_u32 vcc, 0, v60
s_cbranch_vccnz L_rp4F
s_branch L_bp4F
L_rp5F:
s_lshl1_add_u32 s51, s98, 57344
buffer_load_dwordx4 v[224:227], v108, s[88:91], s51 offen sc1
buffer_load_dwordx4 v[228:231], v109, s[88:91], s51 offen sc1
s_add_u32 s99, s99, 1
s_waitcnt vmcnt(0)
s_cmp_gt_u32 s99, 0x8000
s_cbranch_scc1 L_bp5F
v_bitop3_b32 v60, v107, v226, v230 bitop3:0x7e
v_and_b32 v60, s82, v60
v_cmp_ne_u32 vcc, 0, v60
s_cbranch_vccnz L_rp5F
s_branch L_bp5F
.section .rodata,"a"
.p2align 6
.amdhsa_kernel gated_mix__ssm_conv_s5__dense_activation_mish__prompt_kernel
  .amdhsa_next_free_vgpr 512
  .amdhsa_next_free_sgpr 102
  .amdhsa_accum_offset 256
  .amdhsa_group_segment_fixed_size 0
  .amdhsa_kernarg_size 136
  .amdhsa_user_sgpr_count 2
  .amdhsa_user_sgpr_kernarg_segment_ptr 1
  .amdhsa_system_sgpr_workgroup_id_x 1
.end_amdhsa_kernel
```
